```python
import torch

def _softmax(x, axis=-1):
    return torch.softmax(x, dim=axis)
def _gelu(x):
    return torch.nn.functional.gelu(x, approximate="tanh")
def _silu(x):
    return torch.nn.functional.silu(x)
def _sigmoid(x):
    return torch.sigmoid(x)
def _layernorm(x, axis=-1, eps=1e-5):
    m = x.mean(dim=axis, keepdim=True)
    v = x.var(dim=axis, keepdim=True, unbiased=False)
    return (x - m) / torch.sqrt(v + eps)
def _scatter_add(tgt, idx, src, axis=0):
    return tgt.clone().index_add_(axis, idx, src)
def _segment_sum(src, seg, n):
    out = torch.zeros((n,) + src.shape[1:], dtype=src.dtype)
    return out.index_add_(0, seg, src)
def _pad(x, pw):
    flat = tuple(v for pair in reversed(pw) for v in pair)
    return torch.nn.functional.pad(x, flat)

kernel_name = 'gated_mix__sliding_block_cached__gqa_block_cached__decode'

def setup_inputs():

    _w = (lambda a: (lambda t: t.to(torch.bfloat16) if t.is_floating_point() else t)(torch.as_tensor(a)))
    def _A_setup():
        B, Sq, D = 1, 1, 640
        Hq, Hkv, Sk, Dh = 32, 32, 4096, 192
        assert Hq % Hkv == 0, (Hq, Hkv)
        return {
            "x": _w((lambda *s: torch.randn(*s, dtype=torch.bfloat16) * 0.05)(B, Sq, D)),
            "k_cache": _w((lambda *s: torch.randn(*s, dtype=torch.bfloat16) * 6.4)(B, Hkv, Sk, Dh)),
            "v_cache": _w((lambda *s: torch.randn(*s, dtype=torch.bfloat16) * 0.05)(B, Hkv, Sk, Dh)),
            "wq": _w((lambda *s: torch.randn(*s, dtype=torch.bfloat16) * 6.4)(D, Hq * Dh) * (D ** -0.5)),
            "wo": _w((lambda *s: torch.randn(*s, dtype=torch.bfloat16) * 0.05)(Hq * Dh, D) * ((Hq * Dh) ** -0.5)),
        }
    _A_in = _A_setup()

    def _B_setup():
        B, Sq, D = 1, 1, 640
        Hq, Hkv, Sk, Dh = 32, 32, 4096, 192
        assert Hq % Hkv == 0, (Hq, Hkv)
        return {
            "x": _w((lambda *s: torch.randn(*s, dtype=torch.bfloat16) * 0.05)(B, Sq, D)),
            "k_cache": _w((lambda *s: torch.randn(*s, dtype=torch.bfloat16) * 6.4)(B, Hkv, Sk, Dh)),
            "v_cache": _w((lambda *s: torch.randn(*s, dtype=torch.bfloat16) * 0.05)(B, Hkv, Sk, Dh)),
            "wq": _w((lambda *s: torch.randn(*s, dtype=torch.bfloat16) * 6.4)(D, Hq * Dh) * (D ** -0.5)),
            "wo": _w((lambda *s: torch.randn(*s, dtype=torch.bfloat16) * 0.05)(Hq * Dh, D) * ((Hq * Dh) ** -0.5)),
        }
    _B_in = _B_setup()

    return {
        "A_x": _A_in["x"],
        "A_k_cache": _A_in["k_cache"],
        "A_v_cache": _A_in["v_cache"],
        "A_wq": _A_in["wq"],
        "A_wo": _A_in["wo"],
        "B_x": _B_in["x"],
        "B_k_cache": _B_in["k_cache"],
        "B_v_cache": _B_in["v_cache"],
        "B_wq": _B_in["wq"],
        "B_wo": _B_in["wo"],
        "gate_w": _w((lambda *s: torch.randn(*s, dtype=torch.bfloat16) * 0.05)(640) * 16.0),
    }

def reference(A_x, A_k_cache, A_v_cache, A_wq, A_wo, B_x, B_k_cache, B_v_cache, B_wq, B_wo, gate_w):
    def _A_ref(x, k_cache, v_cache, wq, wo):
        B, Sq, D = x.shape
        Hq, Dh = 32, 192
        Hkv, Sk = k_cache.shape[1], k_cache.shape[2]
        W = min(4096, max(256, Sk // 4))
        rep = Hq // Hkv
        q = (lambda x, *d: x.permute(*d))((x @ wq).reshape(B, Sq, Hq, Dh), 0, 2, 1, 3)
        k = (lambda x, n, axis: torch.repeat_interleave(x, n, dim=axis))(k_cache[:, :, Sk - W:, :], rep, axis=1)
        v = (lambda x, n, axis: torch.repeat_interleave(x, n, dim=axis))(v_cache[:, :, Sk - W:, :], rep, axis=1)
        scores = torch.einsum("bhqd,bhkd->bhqk", q, k) * (Dh ** -0.5)
        p = _softmax(scores, axis=-1)
        o = torch.einsum("bhqk,bhkd->bhqd", p, v)
        return (lambda x, *d: x.permute(*d))(o, 0, 2, 1, 3).reshape(B, Sq, Hq * Dh) @ wo

    def _B_ref(x, k_cache, v_cache, wq, wo):
        B, Sq, D = x.shape
        Hq, Dh = 32, 192
        Hkv = k_cache.shape[1]
        rep = Hq // Hkv
        q = (lambda x, *d: x.permute(*d))((x @ wq).reshape(B, Sq, Hq, Dh), 0, 2, 1, 3)
        k = (lambda x, n, axis: torch.repeat_interleave(x, n, dim=axis))(k_cache, rep, axis=1)
        v = (lambda x, n, axis: torch.repeat_interleave(x, n, dim=axis))(v_cache, rep, axis=1)
        scores = torch.einsum("bhqd,bhkd->bhqk", q, k) * (Dh ** -0.5)
        p = _softmax(scores, axis=-1)
        o = torch.einsum("bhqk,bhkd->bhqd", p, v)
        return (lambda x, *d: x.permute(*d))(o, 0, 2, 1, 3).reshape(B, Sq, Hq * Dh) @ wo

    x = A_x
    g = _sigmoid((x * gate_w).sum(-1, keepdims=True))
    a = _A_ref(x, A_k_cache, A_v_cache, A_wq, A_wo)
    b = _B_ref(x, B_k_cache, B_v_cache, B_wq, B_wo)
    return g * a + (1 - g) * b
```

```asm
; @launch grid=(256,1,1) block=(512,1,1) lds=28304
.amdgcn_target "amdgcn-amd-amdhsa--gfx950"
.text
.globl gated_mix__sliding_block_cached__gqa_block_cached__decode_kernel
.p2align 8
.type gated_mix__sliding_block_cached__gqa_block_cached__decode_kernel,@function
gated_mix__sliding_block_cached__gqa_block_cached__decode_kernel:
    s_cmp_ge_u32 s2, 256
    s_cbranch_scc1 L_exit
    s_load_dwordx16 s[4:19], s[0:1], 0
    s_load_dwordx8 s[20:27], s[0:1], 64
    s_load_dwordx4 s[28:31], s[0:1], 96
    v_lshrrev_b32 v68, 6, v0
    v_and_b32 v1, 63, v0
    v_readfirstlane_b32 s76, v68
    v_and_b32 v3, 15, v0
    v_lshrrev_b32 v2, 4, v1
    s_and_b32 s80, s2, 7
    s_lshl_b32 s80, s80, 2
    s_bfe_u32 s81, s2, 0x20003
    s_add_u32 s77, s80, s81
    s_lshr_b32 s78, s2, 5
    s_and_b32 s79, s78, 3
    s_lshl_b32 s80, s76, 2
    s_lshr_b32 s100, 0x54443620, s80
    s_and_b32 s100, s100, 15
    s_cmp_lt_u32 s2, 160
    s_cselect_b32 s80, 1, 2
    s_cmp_eq_u32 s76, 1
    s_cselect_b32 s100, s80, s100
    s_lshl_b32 s100, 1, s100
    s_mul_i32 s80, s79, 160
    s_mul_i32 s81, s76, 20
    s_add_u32 s80, s80, s81
    v_lshl_add_u32 v68, v3, 2, v2
    v_add_u32 v68, s80, v68
    v_lshlrev_b32 v68, 1, v68
    v_mul_u32_u24 v70, 0x3000, v2
    v_lshl_add_u32 v4, v3, 4, v70
    v_lshl_add_u32 v5, v3, 3, v70
    v_add_u32 v5, 0x100, v5
    v_mul_u32_u24 v70, 0x180, v2
    v_lshl_add_u32 v6, v3, 4, v70
    v_lshl_add_u32 v7, v3, 3, v70
    v_add_u32 v7, 0x100, v7
    s_mul_i32 s80, s80, 12288
    s_mul_i32 s81, s77, 384
    s_add_u32 s80, s80, s81
    s_lshl_b32 s81, s78, 3
    s_add_u32 s81, s81, s76
    s_mul_i32 s83, s77, 0x180000
    s_mul_i32 s82, s81, 24576
    s_add_u32 s82, s82, s83
    s_mul_i32 s81, s81, 6144
    s_add_u32 s83, s83, s81
    s_add_u32 s83, s83, 1179648
    s_cmp_lt_u32 s78, 4
    s_waitcnt lgkmcnt(0)
    s_cselect_b32 s32, s20, s10
    s_cselect_b32 s33, s21, s11
    s_cselect_b32 s52, s22, s12
    s_cselect_b32 s53, s23, s13
    s_add_u32 s32, s32, s80
    s_addc_u32 s33, s33, 0
    s_mov_b32 s34, 0x39180
    s_mov_b32 s35, 0x20000
    s_mov_b32 s64, s4
    s_mov_b32 s65, s5
    s_mov_b32 s66, 0x500
    s_mov_b32 s67, 0x20000
    buffer_load_ushort v26, v68, s[64:67], 0 offen
    s_add_u32 s36, s16, s82
    s_addc_u32 s37, s17, 0
    s_mov_b32 s38, 0x6000
    s_mov_b32 s39, 0x20000
    buffer_load_dwordx4 v[92:95], v4, s[32:35], 0 offen nt
    buffer_load_dwordx2 v[96:97], v5, s[32:35], 0 offen nt
    s_mov_b32 s84, 49152
    buffer_load_dwordx4 v[98:101], v4, s[32:35], s84 offen nt
    buffer_load_dwordx2 v[102:103], v5, s[32:35], s84 offen nt
    s_add_u32 s40, s6, s83
    s_addc_u32 s41, s7, 0
    s_mov_b32 s42, 0x1800
    s_mov_b32 s43, 0x20000
    s_add_u32 s44, s18, s82
    s_addc_u32 s45, s19, 0
    s_mov_b32 s46, 0x6000
    s_mov_b32 s47, 0x20000
    s_add_u32 s48, s8, s83
    s_addc_u32 s49, s9, 0
    s_mov_b32 s50, 0x1800
    s_mov_b32 s51, 0x20000
    s_mov_b32 s56, s30
    s_mov_b32 s57, s31
    s_mov_b32 s58, 0x10000000
    s_mov_b32 s59, 0x20000
    s_mov_b32 s60, s28
    s_mov_b32 s61, s29
    s_mov_b32 s62, 0x100
    s_mov_b32 s63, 0x20000
    s_mov_b32 s68, s24
    s_mov_b32 s69, s25
    s_mov_b32 s70, 0x500
    s_mov_b32 s71, 0x20000
    s_mov_b32 s72, s26
    s_mov_b32 s73, s27
    s_mov_b32 s74, 0x500
    s_mov_b32 s75, 0x20000
    s_mov_b32 s54, 0x780000
    s_mov_b32 s55, 0x20000
    s_lshr_b32 s80, s78, 2
    s_lshl_b32 s81, s77, 1
    s_add_u32 s82, s81, s80
    s_mul_i32 s86, s82, 3072
    s_mul_i32 s83, s79, 768
    s_add_u32 s86, s86, s83
    s_lshl_b32 s89, s80, 3
    s_add_u32 s89, s89, s76
    s_lshl_b32 s89, s89, 10
    s_add_u32 s89, s89, 0x40000
    s_lshl_b32 s83, s80, 9
    s_lshl_b32 s88, s77, 4
    s_sub_u32 s88, s88, s83
    s_mul_i32 s83, s79, 40960
    s_add_u32 s88, s88, s83
    s_add_u32 s88, s88, 0xc0200
    s_and_b32 s83, s76, 1
    s_add_u32 s82, s81, s83
    s_lshl_b32 s87, s82, 13
    s_lshl_b32 s83, s78, 7
    s_add_u32 s87, s87, s83
    s_add_u32 s87, s87, 0x40000
    s_mul_i32 s91, s82, 3072
    s_lshl_b32 s92, s77, 3
    s_lshl_b32 s90, s2, 10
    s_add_u32 s90, s90, 0xc0000
    v_lshlrev_b32 v12, 4, v1
    v_mul_u32_u24 v68, 43, v1
    v_lshrrev_b32 v68, 8, v68
    v_mul_u32_u24 v69, 6, v68
    v_sub_u32 v69, v1, v69
    v_lshlrev_b32 v69, 4, v69
    v_lshl_add_u32 v68, v68, 10, v69
    v_and_b32 v69, 7, v1
    v_lshlrev_b32 v69, 10, v69
    v_lshrrev_b32 v70, 3, v1
    v_lshl_add_u32 v69, v70, 4, v69
    v_cmp_gt_u32 vcc, 48, v1
    s_nop 1
    v_cndmask_b32 v14, v69, v68, vcc
    v_mov_b32 v71, 0x40000000
    v_cndmask_b32 v13, v71, v12, vcc
    v_lshlrev_b32 v70, 4, v70
    v_add_u32 v70, 672, v70
    v_cndmask_b32 v10, v70, v12, vcc
    v_lshlrev_b32 v68, 10, v1
    v_cmp_gt_u32 vcc, 40, v1
    s_nop 1
    v_cndmask_b32 v15, v71, v68, vcc
    s_lshr_b32 s80, s2, 7
    s_lshl_b32 s80, s80, 1
    s_bfe_u32 s81, s2, 0x10003
    s_add_u32 s80, s80, s81
    s_mul_i32 s96, s80, 0x1100
    s_add_u32 s96, s96, 0x100000
    s_cmp_lg_u32 s76, 7
    s_cbranch_scc1 L_noclear
    v_mov_b32 v76, -1
    v_mov_b32 v77, -1
    v_mov_b32 v78, -1
    v_mov_b32 v79, -1
    s_sub_u32 s80, s87, 8192
    buffer_store_dwordx4 v[76:79], v14, s[56:59], s80 offen sc1
    buffer_store_dwordx4 v[76:79], v14, s[56:59], s87 offen sc1
    buffer_store_dwordx4 v[76:79], v15, s[56:59], s88 offen sc1
    s_and_b32 s80, s2, 0x77
    s_cmp_eq_u32 s80, 0
    s_cselect_b32 s80, s96, 0x40000000
    v_mov_b32 v68, s80
    v_mov_b32 v69, 0x40000000
    v_cmp_eq_u32 vcc, 0, v1
    s_nop 1
    v_cndmask_b32 v68, v69, v68, vcc
    v_mov_b32 v80, 0
    buffer_store_dword v80, v68, s[56:59], 0 offen sc1
L_noclear:
    s_cmp_lg_u32 s76, 2
    s_cbranch_scc1 L_nosent
    v_mov_b32 v68, -1
    v_mov_b32 v69, 0
    ds_write_b32 v69, v68 offset:28288
L_nosent:
    v_mov_b32 v28, 0
    v_mov_b32 v29, 0
    v_mov_b32 v30, 0
    v_mov_b32 v31, 0
    v_mov_b32 v32, 0
    v_mov_b32 v33, 0
    v_mov_b32 v34, 0
    v_mov_b32 v35, 0
    v_mov_b32 v36, 0
    v_mov_b32 v37, 0
    v_mov_b32 v38, 0
    v_mov_b32 v39, 0
    s_mul_i32 s80, s76, 800
    v_mul_u32_u24 v68, 3, v2
    v_lshl_add_u32 v69, v3, 3, v68
    v_lshl_add_u32 v70, v3, 2, v68
    v_add_u32 v70, 120, v70
    v_cmp_gt_u32 vcc, 8, v68
    s_nop 1
    v_cndmask_b32 v69, v70, v69, vcc
    v_lshlrev_b32 v69, 2, v69
    v_add_u32 v8, s80, v69
    v_add_u32 v68, 2, v68
    v_lshl_add_u32 v69, v3, 3, v68
    v_lshl_add_u32 v70, v3, 2, v68
    v_add_u32 v70, 120, v70
    v_cmp_gt_u32 vcc, 8, v68
    s_nop 1
    v_cndmask_b32 v69, v70, v69, vcc
    v_lshlrev_b32 v69, 2, v69
    v_add_u32 v9, s80, v69
    s_mov_b32 s80, 12800
    s_bitcmp1_b32 s76, 0
    s_cselect_b32 s80, 6400, s80
    v_add_u32 v11, s80, v10
    s_mul_i32 s80, s76, 640
    v_lshrrev_b32 v71, 1, v2
    v_mul_u32_u24 v71, 5, v71
    v_and_b32 v72, 1, v2
    v_lshlrev_b32 v71, 9, v2
    v_and_b32 v71, 0x400, v71
    v_lshrrev_b32 v71, 1, v71
    v_lshl_add_u32 v71, v72, 4, v71
    v_lshl_add_u32 v71, v3, 5, v71
    s_lshl_b32 s80, s76, 10
    v_add_u32 v16, s80, v71
    s_lshl_b32 s80, s2, 3
    v_lshlrev_b32 v68, 1, v2
    v_add_u32 v68, s80, v68
    v_mov_b32 v69, 0x40000000
    v_cmp_eq_u32 vcc, 0, v3
    s_nop 1
    v_cndmask_b32 v19, v69, v68, vcc
    s_cmp_lg_u32 s76, 1
    s_cbranch_scc1 L_nogl
    s_cmp_ge_u32 s2, 160
    s_cbranch_scc1 L_nogl
    v_lshlrev_b32 v69, 2, v1
    buffer_load_dwordx4 v[76:79], v12, s[64:67], 0 offen
    buffer_load_dword v80, v69, s[64:67], 0 offen offset:1024
    buffer_load_dwordx4 v[82:85], v12, s[68:71], 0 offen
    buffer_load_dword v86, v69, s[68:71], 0 offen offset:1024
L_nogl:
    s_mov_b32 s84, 98304
    buffer_load_dwordx4 v[104:107], v4, s[32:35], s84 offen nt
    buffer_load_dwordx2 v[108:109], v5, s[32:35], s84 offen nt
    s_waitcnt vmcnt(6)
    s_and_b32 s101, s100, 34
    s_cbranch_scc1 L_vm1
    s_waitcnt vmcnt(2)
L_vm1:
    s_mov_b32 s84, 147456
    buffer_load_dwordx4 v[110:113], v4, s[32:35], s84 offen nt
    buffer_load_dwordx2 v[114:115], v5, s[32:35], s84 offen nt
    v_lshlrev_b32 v27, 16, v26
    v_dot2c_f32_bf16_dpp v28, v26, v92 row_newbcast:0 row_mask:0xf bank_mask:0xf
    s_nop 0
    v_dot2c_f32_bf16_dpp v29, v27, v92 row_newbcast:0 row_mask:0xf bank_mask:0xf
    v_dot2c_f32_bf16_dpp v30, v26, v93 row_newbcast:0 row_mask:0xf bank_mask:0xf
    v_dot2c_f32_bf16_dpp v31, v27, v93 row_newbcast:0 row_mask:0xf bank_mask:0xf
    v_dot2c_f32_bf16_dpp v32, v26, v94 row_newbcast:0 row_mask:0xf bank_mask:0xf
    v_dot2c_f32_bf16_dpp v33, v27, v94 row_newbcast:0 row_mask:0xf bank_mask:0xf
    v_dot2c_f32_bf16_dpp v34, v26, v95 row_newbcast:0 row_mask:0xf bank_mask:0xf
    v_dot2c_f32_bf16_dpp v35, v27, v95 row_newbcast:0 row_mask:0xf bank_mask:0xf
    v_dot2c_f32_bf16_dpp v36, v26, v96 row_newbcast:0 row_mask:0xf bank_mask:0xf
    v_dot2c_f32_bf16_dpp v37, v27, v96 row_newbcast:0 row_mask:0xf bank_mask:0xf
    v_dot2c_f32_bf16_dpp v38, v26, v97 row_newbcast:0 row_mask:0xf bank_mask:0xf
    v_dot2c_f32_bf16_dpp v39, v27, v97 row_newbcast:0 row_mask:0xf bank_mask:0xf
    v_dot2c_f32_bf16_dpp v28, v26, v98 row_newbcast:1 row_mask:0xf bank_mask:0xf
    v_dot2c_f32_bf16_dpp v29, v27, v98 row_newbcast:1 row_mask:0xf bank_mask:0xf
    v_dot2c_f32_bf16_dpp v30, v26, v99 row_newbcast:1 row_mask:0xf bank_mask:0xf
    v_dot2c_f32_bf16_dpp v31, v27, v99 row_newbcast:1 row_mask:0xf bank_mask:0xf
    v_dot2c_f32_bf16_dpp v32, v26, v100 row_newbcast:1 row_mask:0xf bank_mask:0xf
    v_dot2c_f32_bf16_dpp v33, v27, v100 row_newbcast:1 row_mask:0xf bank_mask:0xf
    v_dot2c_f32_bf16_dpp v34, v26, v101 row_newbcast:1 row_mask:0xf bank_mask:0xf
    v_dot2c_f32_bf16_dpp v35, v27, v101 row_newbcast:1 row_mask:0xf bank_mask:0xf
    v_dot2c_f32_bf16_dpp v36, v26, v102 row_newbcast:1 row_mask:0xf bank_mask:0xf
    v_dot2c_f32_bf16_dpp v37, v27, v102 row_newbcast:1 row_mask:0xf bank_mask:0xf
    v_dot2c_f32_bf16_dpp v38, v26, v103 row_newbcast:1 row_mask:0xf bank_mask:0xf
    v_dot2c_f32_bf16_dpp v39, v27, v103 row_newbcast:1 row_mask:0xf bank_mask:0xf
    s_waitcnt vmcnt(2)
    s_mov_b32 s84, 196608
    buffer_load_dwordx4 v[116:119], v4, s[32:35], s84 offen nt
    buffer_load_dwordx2 v[120:121], v5, s[32:35], s84 offen nt
    v_dot2c_f32_bf16_dpp v28, v26, v104 row_newbcast:2 row_mask:0xf bank_mask:0xf
    v_dot2c_f32_bf16_dpp v29, v27, v104 row_newbcast:2 row_mask:0xf bank_mask:0xf
    v_dot2c_f32_bf16_dpp v30, v26, v105 row_newbcast:2 row_mask:0xf bank_mask:0xf
    v_dot2c_f32_bf16_dpp v31, v27, v105 row_newbcast:2 row_mask:0xf bank_mask:0xf
    v_dot2c_f32_bf16_dpp v32, v26, v106 row_newbcast:2 row_mask:0xf bank_mask:0xf
    v_dot2c_f32_bf16_dpp v33, v27, v106 row_newbcast:2 row_mask:0xf bank_mask:0xf
    v_dot2c_f32_bf16_dpp v34, v26, v107 row_newbcast:2 row_mask:0xf bank_mask:0xf
    v_dot2c_f32_bf16_dpp v35, v27, v107 row_newbcast:2 row_mask:0xf bank_mask:0xf
    v_dot2c_f32_bf16_dpp v36, v26, v108 row_newbcast:2 row_mask:0xf bank_mask:0xf
    v_dot2c_f32_bf16_dpp v37, v27, v108 row_newbcast:2 row_mask:0xf bank_mask:0xf
    v_dot2c_f32_bf16_dpp v38, v26, v109 row_newbcast:2 row_mask:0xf bank_mask:0xf
    v_dot2c_f32_bf16_dpp v39, v27, v109 row_newbcast:2 row_mask:0xf bank_mask:0xf
    s_waitcnt vmcnt(2)
    buffer_load_dwordx4 v[122:125], v6, s[36:39], 0 offen offset:0 nt
    buffer_load_dwordx2 v[126:127], v7, s[36:39], 0 offen offset:0 nt
    v_dot2c_f32_bf16_dpp v28, v26, v110 row_newbcast:3 row_mask:0xf bank_mask:0xf
    v_dot2c_f32_bf16_dpp v29, v27, v110 row_newbcast:3 row_mask:0xf bank_mask:0xf
    v_dot2c_f32_bf16_dpp v30, v26, v111 row_newbcast:3 row_mask:0xf bank_mask:0xf
    v_dot2c_f32_bf16_dpp v31, v27, v111 row_newbcast:3 row_mask:0xf bank_mask:0xf
    v_dot2c_f32_bf16_dpp v32, v26, v112 row_newbcast:3 row_mask:0xf bank_mask:0xf
    v_dot2c_f32_bf16_dpp v33, v27, v112 row_newbcast:3 row_mask:0xf bank_mask:0xf
    v_dot2c_f32_bf16_dpp v34, v26, v113 row_newbcast:3 row_mask:0xf bank_mask:0xf
    v_dot2c_f32_bf16_dpp v35, v27, v113 row_newbcast:3 row_mask:0xf bank_mask:0xf
    v_dot2c_f32_bf16_dpp v36, v26, v114 row_newbcast:3 row_mask:0xf bank_mask:0xf
    v_dot2c_f32_bf16_dpp v37, v27, v114 row_newbcast:3 row_mask:0xf bank_mask:0xf
    v_dot2c_f32_bf16_dpp v38, v26, v115 row_newbcast:3 row_mask:0xf bank_mask:0xf
    v_dot2c_f32_bf16_dpp v39, v27, v115 row_newbcast:3 row_mask:0xf bank_mask:0xf
    s_waitcnt vmcnt(2)
    buffer_load_dwordx4 v[128:131], v6, s[36:39], 0 offen offset:1536 nt
    buffer_load_dwordx2 v[132:133], v7, s[36:39], 0 offen offset:1536 nt
    v_dot2c_f32_bf16_dpp v28, v26, v116 row_newbcast:4 row_mask:0xf bank_mask:0xf
    v_dot2c_f32_bf16_dpp v29, v27, v116 row_newbcast:4 row_mask:0xf bank_mask:0xf
    v_dot2c_f32_bf16_dpp v30, v26, v117 row_newbcast:4 row_mask:0xf bank_mask:0xf
    v_dot2c_f32_bf16_dpp v31, v27, v117 row_newbcast:4 row_mask:0xf bank_mask:0xf
    v_dot2c_f32_bf16_dpp v32, v26, v118 row_newbcast:4 row_mask:0xf bank_mask:0xf
    v_dot2c_f32_bf16_dpp v33, v27, v118 row_newbcast:4 row_mask:0xf bank_mask:0xf
    v_dot2c_f32_bf16_dpp v34, v26, v119 row_newbcast:4 row_mask:0xf bank_mask:0xf
    v_dot2c_f32_bf16_dpp v35, v27, v119 row_newbcast:4 row_mask:0xf bank_mask:0xf
    v_dot2c_f32_bf16_dpp v36, v26, v120 row_newbcast:4 row_mask:0xf bank_mask:0xf
    v_dot2c_f32_bf16_dpp v37, v27, v120 row_newbcast:4 row_mask:0xf bank_mask:0xf
    v_dot2c_f32_bf16_dpp v38, v26, v121 row_newbcast:4 row_mask:0xf bank_mask:0xf
    v_dot2c_f32_bf16_dpp v39, v27, v121 row_newbcast:4 row_mask:0xf bank_mask:0xf
    v_permlane32_swap_b32 v28, v34
    v_permlane32_swap_b32 v29, v35
    v_permlane32_swap_b32 v30, v36
    v_permlane32_swap_b32 v31, v37
    v_permlane32_swap_b32 v32, v38
    v_permlane32_swap_b32 v33, v39
    v_add_f32 v28, v28, v34
    v_add_f32 v29, v29, v35
    v_add_f32 v30, v30, v36
    v_add_f32 v31, v31, v37
    v_add_f32 v32, v32, v38
    v_add_f32 v33, v33, v39
    v_permlane16_swap_b32 v28, v31
    v_permlane16_swap_b32 v29, v32
    v_permlane16_swap_b32 v30, v33
    v_add_f32 v28, v28, v31
    v_add_f32 v29, v29, v32
    v_add_f32 v30, v30, v33
    ds_write_b32 v8, v28 offset:0
    ds_write_b32 v8, v29 offset:4
    ds_write_b32 v9, v30 offset:0
    v_mov_b32 v28, 0
    v_mov_b32 v29, 0
    v_mov_b32 v30, 0
    v_mov_b32 v31, 0
    v_mov_b32 v32, 0
    v_mov_b32 v33, 0
    v_mov_b32 v34, 0
    v_mov_b32 v35, 0
    v_mov_b32 v36, 0
    v_mov_b32 v37, 0
    v_mov_b32 v38, 0
    v_mov_b32 v39, 0
    s_waitcnt vmcnt(10)
    s_waitcnt lgkmcnt(0)
    s_barrier
    s_cmp_lg_u32 s76, 0
    s_cbranch_scc1 L_noq0
    ds_read_b128 v[146:149], v10 offset:0
    ds_read_b128 v[150:153], v10 offset:800
    ds_read_b128 v[154:157], v10 offset:1600
    ds_read_b128 v[158:161], v10 offset:2400
    ds_read_b128 v[162:165], v10 offset:3200
    ds_read_b128 v[166:169], v10 offset:4000
    ds_read_b128 v[170:173], v10 offset:4800
    ds_read_b128 v[174:177], v10 offset:5600
    s_waitcnt lgkmcnt(6)
    v_pk_add_f32 v[146:147], v[146:147], v[150:151]
    v_pk_add_f32 v[148:149], v[148:149], v[152:153]
    s_waitcnt lgkmcnt(4)
    v_pk_add_f32 v[154:155], v[154:155], v[158:159]
    v_pk_add_f32 v[156:157], v[156:157], v[160:161]
    s_waitcnt lgkmcnt(2)
    v_pk_add_f32 v[162:163], v[162:163], v[166:167]
    v_pk_add_f32 v[164:165], v[164:165], v[168:169]
    v_pk_add_f32 v[146:147], v[146:147], v[154:155]
    v_pk_add_f32 v[148:149], v[148:149], v[156:157]
    s_waitcnt lgkmcnt(0)
    v_pk_add_f32 v[170:171], v[170:171], v[174:175]
    v_pk_add_f32 v[172:173], v[172:173], v[176:177]
    v_pk_add_f32 v[162:163], v[162:163], v[170:171]
    v_pk_add_f32 v[164:165], v[164:165], v[172:173]
    v_pk_add_f32 v[146:147], v[146:147], v[162:163]
    v_pk_add_f32 v[148:149], v[148:149], v[164:165]
    buffer_store_dwordx4 v[146:149], v13, s[56:59], s86 offen sc1
L_noq0:
    s_cmp_lg_u32 s76, 1
    s_cbranch_scc1 L_nogate
    s_cmp_ge_u32 s2, 160
    s_cbranch_scc1 L_nogate
    s_waitcnt vmcnt(10)
    v_mov_b32 v20, 0
    s_mov_b32 s80, 0xffff0000
    v_mov_b32 v21, 0x3f803f80
    v_lshlrev_b32 v68, 16, v76
    v_lshlrev_b32 v69, 16, v82
    v_and_b32 v70, s80, v76
    v_and_b32 v71, s80, v82
    v_mul_f32 v68, v68, v69
    v_mul_f32 v70, v70, v71
    v_cvt_pk_bf16_f32 v68, v68, v70
    v_dot2c_f32_bf16 v20, v68, v21
    v_lshlrev_b32 v68, 16, v77
    v_lshlrev_b32 v69, 16, v83
    v_and_b32 v70, s80, v77
    v_and_b32 v71, s80, v83
    v_mul_f32 v68, v68, v69
    v_mul_f32 v70, v70, v71
    v_cvt_pk_bf16_f32 v68, v68, v70
    v_dot2c_f32_bf16 v20, v68, v21
    v_lshlrev_b32 v68, 16, v78
    v_lshlrev_b32 v69, 16, v84
    v_and_b32 v70, s80, v78
    v_and_b32 v71, s80, v84
    v_mul_f32 v68, v68, v69
    v_mul_f32 v70, v70, v71
    v_cvt_pk_bf16_f32 v68, v68, v70
    v_dot2c_f32_bf16 v20, v68, v21
    v_lshlrev_b32 v68, 16, v79
    v_lshlrev_b32 v69, 16, v85
    v_and_b32 v70, s80, v79
    v_and_b32 v71, s80, v85
    v_mul_f32 v68, v68, v69
    v_mul_f32 v70, v70, v71
    v_cvt_pk_bf16_f32 v68, v68, v70
    v_dot2c_f32_bf16 v20, v68, v21
    v_lshlrev_b32 v68, 16, v80
    v_lshlrev_b32 v69, 16, v86
    v_and_b32 v70, s80, v80
    v_and_b32 v71, s80, v86
    v_mul_f32 v68, v68, v69
    v_mul_f32 v70, v70, v71
    v_cvt_pk_bf16_f32 v68, v68, v70
    v_dot2c_f32_bf16 v20, v68, v21
    s_nop 2
    v_add_f32_dpp v20, v20, v20 row_ror:1 row_mask:0xf bank_mask:0xf
    s_nop 1
    v_add_f32_dpp v20, v20, v20 row_ror:2 row_mask:0xf bank_mask:0xf
    s_nop 1
    v_add_f32_dpp v20, v20, v20 row_ror:4 row_mask:0xf bank_mask:0xf
    s_nop 1
    v_add_f32_dpp v20, v20, v20 row_ror:8 row_mask:0xf bank_mask:0xf
    v_mov_b32 v68, v20
    s_nop 1
    v_permlane16_swap_b32 v20, v68
    v_add_f32 v20, v20, v68
    v_mov_b32 v68, v20
    s_nop 1
    v_permlane32_swap_b32 v20, v68
    v_add_f32 v20, v20, v68
    v_cvt_pk_bf16_f32 v20, 0, v20
    v_mul_f32 v20, 0xbfb8aa3b, v20
    v_exp_f32 v20, v20
    s_nop 0
    v_add_f32 v20, 1.0, v20
    v_rcp_f32 v20, v20
    s_nop 0
    v_cvt_pk_bf16_f32 v20, 0, v20
    v_sub_f32 v21, 1.0, v20
    v_cvt_pk_bf16_f32 v21, 0, v21
L_nogate:
    s_waitcnt vmcnt(3)
    s_bitcmp1_b32 s100, 0
    s_cbranch_scc1 L_vm2
    s_waitcnt vmcnt(2)
L_vm2:
    buffer_load_dwordx4 v[134:137], v6, s[36:39], 0 offen offset:3072 nt
    buffer_load_dwordx2 v[138:139], v7, s[36:39], 0 offen offset:3072 nt
    s_waitcnt vmcnt(3)
    s_bitcmp1_b32 s100, 0
    s_cbranch_scc1 L_vm3
    s_waitcnt vmcnt(2)
L_vm3:
    s_mov_b32 s84, 4608
    buffer_load_dwordx4 v[140:143], v6, s[36:39], s84 offen offset:0 nt
    buffer_load_dwordx2 v[144:145], v7, s[36:39], s84 offen offset:0 nt
    s_waitcnt vmcnt(2)
    buffer_load_dwordx4 v[146:149], v6, s[36:39], s84 offen offset:1536 nt
    buffer_load_dwordx2 v[150:151], v7, s[36:39], s84 offen offset:1536 nt
    s_cmp_lg_u32 s76, 0
    s_cbranch_scc1 L_noflag
    s_waitcnt vmcnt(6)
    s_lshl_b32 s80, s77, 3
    s_add_u32 s80, s80, s78
    v_mov_b32 v68, 1
    s_mov_b64 exec, 1
    s_and_b32 s81, s80, 3
    s_lshl_b32 s81, s81, 3
    s_lshl_b32 s81, 1, s81
    s_and_b32 s80, s80, 0xfc
    v_mov_b32 v68, s81
    buffer_atomic_or v68, off, s[60:63], s80 sc1
    s_mov_b64 exec, -1
L_noflag:
    s_waitcnt vmcnt(3)
    s_bitcmp1_b32 s100, 0
    s_cbranch_scc1 L_vm4
    s_waitcnt vmcnt(2)
L_vm4:
    buffer_load_dwordx4 v[152:155], v6, s[36:39], s84 offen offset:3072 nt
    buffer_load_dwordx2 v[156:157], v7, s[36:39], s84 offen offset:3072 nt
    s_waitcnt vmcnt(3)
    s_bitcmp1_b32 s100, 0
    s_cbranch_scc1 L_vm5
    s_waitcnt vmcnt(2)
L_vm5:
    s_mov_b32 s84, 9216
    buffer_load_dwordx4 v[158:161], v6, s[36:39], s84 offen offset:0 nt
    buffer_load_dwordx2 v[162:163], v7, s[36:39], s84 offen offset:0 nt
    s_waitcnt vmcnt(2)
    buffer_load_dwordx4 v[164:167], v6, s[36:39], s84 offen offset:1536 nt
    buffer_load_dwordx2 v[168:169], v7, s[36:39], s84 offen offset:1536 nt
    s_waitcnt vmcnt(2)
    buffer_load_dwordx4 v[170:173], v6, s[36:39], s84 offen offset:3072 nt
    buffer_load_dwordx2 v[174:175], v7, s[36:39], s84 offen offset:3072 nt
    s_waitcnt vmcnt(2)
    s_mov_b32 s84, 13824
    buffer_load_dwordx4 v[176:179], v6, s[36:39], s84 offen offset:0 nt
    buffer_load_dwordx2 v[180:181], v7, s[36:39], s84 offen offset:0 nt
    s_waitcnt vmcnt(2)
    buffer_load_dwordx4 v[182:185], v6, s[36:39], s84 offen offset:1536 nt
    buffer_load_dwordx2 v[186:187], v7, s[36:39], s84 offen offset:1536 nt
    buffer_load_dword v236, off, s[44:47], 0
    s_cmp_lg_u32 s76, 7
    s_cbranch_scc1 L_nott2
    buffer_load_dword v236, off, s[40:43], 0
    buffer_load_dword v236, off, s[48:51], 0
L_nott2:
    s_waitcnt vmcnt(5)
    s_bitcmp1_b32 s100, 5
    s_cbranch_scc1 L_vm6
    s_waitcnt vmcnt(3)
L_vm6:
    buffer_load_dwordx4 v[188:191], v6, s[36:39], s84 offen offset:3072 nt
    buffer_load_dwordx2 v[192:193], v7, s[36:39], s84 offen offset:3072 nt
    s_waitcnt vmcnt(5)
    s_bitcmp1_b32 s100, 5
    s_cbranch_scc1 L_vm7
    s_waitcnt vmcnt(3)
L_vm7:
    s_mov_b32 s84, 18432
    buffer_load_dwordx4 v[194:197], v6, s[36:39], s84 offen offset:0 nt
    buffer_load_dwordx2 v[198:199], v7, s[36:39], s84 offen offset:0 nt
    s_waitcnt vmcnt(2)
    buffer_load_dwordx4 v[200:203], v6, s[36:39], s84 offen offset:1536 nt
    buffer_load_dwordx2 v[204:205], v7, s[36:39], s84 offen offset:1536 nt
    s_sub_u32 s80, s76, 2
    s_cmp_ge_u32 s80, 2
    s_cbranch_scc1 L_noqf1
    buffer_load_dwordx2 v[76:77], off, s[60:63], s92 sc1
L_noqf1:
    s_waitcnt vmcnt(3)
    s_and_b32 s101, s100, 72
    s_cbranch_scc1 L_vm8
    s_waitcnt vmcnt(2)
L_vm8:
    buffer_load_dwordx4 v[206:209], v6, s[36:39], s84 offen offset:3072 nt
    buffer_load_dwordx2 v[210:211], v7, s[36:39], s84 offen offset:3072 nt
    s_waitcnt vmcnt(3)
    s_and_b32 s101, s100, 72
    s_cbranch_scc1 L_vm9
    s_waitcnt vmcnt(2)
L_vm9:
    s_mov_b32 s84, 23040
    buffer_load_dwordx4 v[212:215], v6, s[36:39], s84 offen offset:0 nt
    buffer_load_dwordx2 v[216:217], v7, s[36:39], s84 offen offset:0 nt
    s_sub_u32 s80, s76, 2
    s_cmp_ge_u32 s80, 2
    s_cbranch_scc1 L_noqf2
    s_waitcnt vmcnt(4)
    v_and_b32 v68, v76, v77
    v_cmp_ne_u32 vcc, 0x01010101, v68
    s_cbranch_vccz L_ok_fl
    s_mov_b32 s85, 32768
L_spin_fl:
    s_sleep 4
    buffer_load_dwordx2 v[76:77], off, s[60:63], s92 sc1
    s_waitcnt vmcnt(0)
    v_and_b32 v68, v76, v77
    v_cmp_ne_u32 vcc, 0x01010101, v68
    s_cbranch_vccz L_ok_fl
    s_sub_u32 s85, s85, 1
    s_cmp_lg_u32 s85, 0
    s_cbranch_scc1 L_spin_fl
L_ok_fl:
    buffer_load_dwordx4 v[76:79], v13, s[56:59], s91 offen offset:0 sc1
    buffer_load_dwordx4 v[80:83], v13, s[56:59], s91 offen offset:768 sc1
    buffer_load_dwordx4 v[84:87], v13, s[56:59], s91 offen offset:1536 sc1
    buffer_load_dwordx4 v[88:91], v13, s[56:59], s91 offen offset:2304 sc1
L_noqf2:
    s_waitcnt vmcnt(6)
    s_and_b32 s101, s100, 72
    s_cbranch_scc1 L_vm10
    s_waitcnt vmcnt(2)
L_vm10:
    buffer_load_dwordx4 v[218:221], v6, s[40:43], 0 offen offset:0 nt
    buffer_load_dwordx2 v[222:223], v7, s[40:43], 0 offen offset:0 nt
    s_waitcnt vmcnt(6)
    s_and_b32 s101, s100, 72
    s_cbranch_scc1 L_vm11
    s_waitcnt vmcnt(2)
L_vm11:
    buffer_load_dwordx4 v[224:227], v6, s[40:43], 0 offen offset:1536 nt
    buffer_load_dwordx2 v[228:229], v7, s[40:43], 0 offen offset:1536 nt
    s_sub_u32 s80, s76, 2
    s_cmp_ge_u32 s80, 2
    s_cbranch_scc1 L_noqf3
    s_waitcnt vmcnt(4)
    v_pk_add_f32 v[76:77], v[76:77], v[80:81]
    v_pk_add_f32 v[78:79], v[78:79], v[82:83]
    v_pk_add_f32 v[84:85], v[84:85], v[88:89]
    v_pk_add_f32 v[86:87], v[86:87], v[90:91]
    v_pk_add_f32 v[76:77], v[76:77], v[84:85]
    v_pk_add_f32 v[78:79], v[78:79], v[86:87]
    v_cvt_pk_bf16_f32 v76, v76, v77
    v_cvt_pk_bf16_f32 v77, v78, v79
    s_and_b32 s80, s76, 1
    s_mul_i32 s80, s80, 384
    v_lshlrev_b32 v68, 3, v1
    v_add_u32 v68, s80, v68
    s_mov_b32 exec_hi, 0xffff
    ds_write_b64 v68, v[76:77] offset:19200
    s_mov_b32 exec_hi, -1
    s_waitcnt lgkmcnt(0)
L_noqf3:
    s_barrier
    v_lshlrev_b32 v68, 4, v3
    v_lshlrev_b32 v69, 3, v3
    ds_read_b128 v[40:43], v68 offset:19200
    ds_read_b64 v[44:45], v69 offset:19456
    ds_read_b128 v[46:49], v68 offset:19584
    ds_read_b64 v[50:51], v69 offset:19840
    s_waitcnt lgkmcnt(0)
    v_mov_b32 v62, 0
    v_mov_b32 v63, 0
    v_mov_b32 v64, 0
    v_mov_b32 v65, 0
    v_dot2c_f32_bf16 v62, v122, v40
    v_dot2c_f32_bf16 v63, v128, v40
    v_dot2c_f32_bf16 v64, v134, v40
    v_dot2c_f32_bf16 v65, v140, v40
    v_dot2c_f32_bf16 v62, v123, v41
    v_dot2c_f32_bf16 v63, v129, v41
    v_dot2c_f32_bf16 v64, v135, v41
    v_dot2c_f32_bf16 v65, v141, v41
    v_dot2c_f32_bf16 v62, v124, v42
    v_dot2c_f32_bf16 v63, v130, v42
    v_dot2c_f32_bf16 v64, v136, v42
    v_dot2c_f32_bf16 v65, v142, v42
    v_dot2c_f32_bf16 v62, v125, v43
    v_dot2c_f32_bf16 v63, v131, v43
    v_dot2c_f32_bf16 v64, v137, v43
    v_dot2c_f32_bf16 v65, v143, v43
    v_dot2c_f32_bf16 v62, v126, v44
    v_dot2c_f32_bf16 v63, v132, v44
    v_dot2c_f32_bf16 v64, v138, v44
    v_dot2c_f32_bf16 v65, v144, v44
    v_dot2c_f32_bf16 v62, v127, v45
    v_dot2c_f32_bf16 v63, v133, v45
    v_dot2c_f32_bf16 v64, v139, v45
    v_dot2c_f32_bf16 v65, v145, v45
    v_add_f32_dpp v66, v62, v62 row_ror:8 row_mask:0xf bank_mask:0xf
    s_nop 0
    v_add_f32_dpp v67, v64, v64 row_ror:8 row_mask:0xf bank_mask:0xf
    v_add_f32_dpp v66, v63, v63 row_ror:8 row_mask:0xf bank_mask:0xc
    s_nop 0
    v_add_f32_dpp v67, v65, v65 row_ror:8 row_mask:0xf bank_mask:0xc
    v_add_f32_dpp v52, v66, v66 row_half_mirror row_mask:0xf bank_mask:0xf
    s_nop 1
    v_add_f32_dpp v52, v67, v67 row_half_mirror row_mask:0xf bank_mask:0xa
    s_nop 1
    v_add_f32_dpp v52, v52, v52 quad_perm:[2,3,0,1] row_mask:0xf bank_mask:0xf
    s_nop 1
    v_add_f32_dpp v52, v52, v52 quad_perm:[1,0,3,2] row_mask:0xf bank_mask:0xf
    v_cvt_pk_bf16_f32 v52, 0, v52
    v_mul_f32 v52, 0x3d93cd3a, v52
    v_cvt_pk_bf16_f32 v52, 0, v52
    v_mov_b32 v62, 0
    v_mov_b32 v63, 0
    v_mov_b32 v64, 0
    v_mov_b32 v65, 0
    v_dot2c_f32_bf16 v62, v146, v40
    v_dot2c_f32_bf16 v63, v152, v40
    v_dot2c_f32_bf16 v64, v158, v40
    v_dot2c_f32_bf16 v65, v164, v40
    v_dot2c_f32_bf16 v62, v147, v41
    v_dot2c_f32_bf16 v63, v153, v41
    v_dot2c_f32_bf16 v64, v159, v41
    v_dot2c_f32_bf16 v65, v165, v41
    v_dot2c_f32_bf16 v62, v148, v42
    v_dot2c_f32_bf16 v63, v154, v42
    v_dot2c_f32_bf16 v64, v160, v42
    v_dot2c_f32_bf16 v65, v166, v42
    v_dot2c_f32_bf16 v62, v149, v43
    v_dot2c_f32_bf16 v63, v155, v43
    v_dot2c_f32_bf16 v64, v161, v43
    v_dot2c_f32_bf16 v65, v167, v43
    v_dot2c_f32_bf16 v62, v150, v44
    v_dot2c_f32_bf16 v63, v156, v44
    v_dot2c_f32_bf16 v64, v162, v44
    v_dot2c_f32_bf16 v65, v168, v44
    v_dot2c_f32_bf16 v62, v151, v45
    v_dot2c_f32_bf16 v63, v157, v45
    v_dot2c_f32_bf16 v64, v163, v45
    v_dot2c_f32_bf16 v65, v169, v45
    v_add_f32_dpp v66, v62, v62 row_ror:8 row_mask:0xf bank_mask:0xf
    s_nop 0
    v_add_f32_dpp v67, v64, v64 row_ror:8 row_mask:0xf bank_mask:0xf
    v_add_f32_dpp v66, v63, v63 row_ror:8 row_mask:0xf bank_mask:0xc
    s_nop 0
    v_add_f32_dpp v67, v65, v65 row_ror:8 row_mask:0xf bank_mask:0xc
    v_add_f32_dpp v53, v66, v66 row_half_mirror row_mask:0xf bank_mask:0xf
    s_nop 1
    v_add_f32_dpp v53, v67, v67 row_half_mirror row_mask:0xf bank_mask:0xa
    s_nop 1
    v_add_f32_dpp v53, v53, v53 quad_perm:[2,3,0,1] row_mask:0xf bank_mask:0xf
    s_nop 1
    v_add_f32_dpp v53, v53, v53 quad_perm:[1,0,3,2] row_mask:0xf bank_mask:0xf
    v_cvt_pk_bf16_f32 v53, 0, v53
    v_mul_f32 v53, 0x3d93cd3a, v53
    v_cvt_pk_bf16_f32 v53, 0, v53
    buffer_load_dwordx4 v[230:233], v6, s[40:43], 0 offen offset:3072 nt
    buffer_load_dwordx2 v[234:235], v7, s[40:43], 0 offen offset:3072 nt
    v_mov_b32 v62, 0
    v_mov_b32 v63, 0
    v_mov_b32 v64, 0
    v_mov_b32 v65, 0
    v_dot2c_f32_bf16 v62, v170, v40
    v_dot2c_f32_bf16 v63, v176, v40
    v_dot2c_f32_bf16 v64, v182, v40
    v_dot2c_f32_bf16 v65, v188, v40
    v_dot2c_f32_bf16 v62, v171, v41
    v_dot2c_f32_bf16 v63, v177, v41
    v_dot2c_f32_bf16 v64, v183, v41
    v_dot2c_f32_bf16 v65, v189, v41
    v_dot2c_f32_bf16 v62, v172, v42
    v_dot2c_f32_bf16 v63, v178, v42
    v_dot2c_f32_bf16 v64, v184, v42
    v_dot2c_f32_bf16 v65, v190, v42
    v_dot2c_f32_bf16 v62, v173, v43
    v_dot2c_f32_bf16 v63, v179, v43
    v_dot2c_f32_bf16 v64, v185, v43
    v_dot2c_f32_bf16 v65, v191, v43
    v_dot2c_f32_bf16 v62, v174, v44
    v_dot2c_f32_bf16 v63, v180, v44
    v_dot2c_f32_bf16 v64, v186, v44
    v_dot2c_f32_bf16 v65, v192, v44
    v_dot2c_f32_bf16 v62, v175, v45
    v_dot2c_f32_bf16 v63, v181, v45
    v_dot2c_f32_bf16 v64, v187, v45
    v_dot2c_f32_bf16 v65, v193, v45
    v_add_f32_dpp v66, v62, v62 row_ror:8 row_mask:0xf bank_mask:0xf
    s_nop 0
    v_add_f32_dpp v67, v64, v64 row_ror:8 row_mask:0xf bank_mask:0xf
    v_add_f32_dpp v66, v63, v63 row_ror:8 row_mask:0xf bank_mask:0xc
    s_nop 0
    v_add_f32_dpp v67, v65, v65 row_ror:8 row_mask:0xf bank_mask:0xc
    v_add_f32_dpp v54, v66, v66 row_half_mirror row_mask:0xf bank_mask:0xf
    s_nop 1
    v_add_f32_dpp v54, v67, v67 row_half_mirror row_mask:0xf bank_mask:0xa
    s_nop 1
    v_add_f32_dpp v54, v54, v54 quad_perm:[2,3,0,1] row_mask:0xf bank_mask:0xf
    s_nop 1
    v_add_f32_dpp v54, v54, v54 quad_perm:[1,0,3,2] row_mask:0xf bank_mask:0xf
    v_cvt_pk_bf16_f32 v54, 0, v54
    v_mul_f32 v54, 0x3d93cd3a, v54
    v_cvt_pk_bf16_f32 v54, 0, v54
    v_mov_b32 v62, 0
    v_mov_b32 v63, 0
    v_mov_b32 v64, 0
    v_mov_b32 v65, 0
    v_dot2c_f32_bf16 v62, v194, v40
    v_dot2c_f32_bf16 v63, v200, v40
    v_dot2c_f32_bf16 v64, v206, v40
    v_dot2c_f32_bf16 v65, v212, v40
    v_dot2c_f32_bf16 v62, v195, v41
    v_dot2c_f32_bf16 v63, v201, v41
    v_dot2c_f32_bf16 v64, v207, v41
    v_dot2c_f32_bf16 v65, v213, v41
    v_dot2c_f32_bf16 v62, v196, v42
    v_dot2c_f32_bf16 v63, v202, v42
    v_dot2c_f32_bf16 v64, v208, v42
    v_dot2c_f32_bf16 v65, v214, v42
    v_dot2c_f32_bf16 v62, v197, v43
    v_dot2c_f32_bf16 v63, v203, v43
    v_dot2c_f32_bf16 v64, v209, v43
    v_dot2c_f32_bf16 v65, v215, v43
    v_dot2c_f32_bf16 v62, v198, v44
    v_dot2c_f32_bf16 v63, v204, v44
    v_dot2c_f32_bf16 v64, v210, v44
    v_dot2c_f32_bf16 v65, v216, v44
    v_dot2c_f32_bf16 v62, v199, v45
    v_dot2c_f32_bf16 v63, v205, v45
    v_dot2c_f32_bf16 v64, v211, v45
    v_dot2c_f32_bf16 v65, v217, v45
    v_add_f32_dpp v66, v62, v62 row_ror:8 row_mask:0xf bank_mask:0xf
    s_nop 0
    v_add_f32_dpp v67, v64, v64 row_ror:8 row_mask:0xf bank_mask:0xf
    v_add_f32_dpp v66, v63, v63 row_ror:8 row_mask:0xf bank_mask:0xc
    s_nop 0
    v_add_f32_dpp v67, v65, v65 row_ror:8 row_mask:0xf bank_mask:0xc
    v_add_f32_dpp v55, v66, v66 row_half_mirror row_mask:0xf bank_mask:0xf
    s_nop 1
    v_add_f32_dpp v55, v67, v67 row_half_mirror row_mask:0xf bank_mask:0xa
    s_nop 1
    v_add_f32_dpp v55, v55, v55 quad_perm:[2,3,0,1] row_mask:0xf bank_mask:0xf
    s_nop 1
    v_add_f32_dpp v55, v55, v55 quad_perm:[1,0,3,2] row_mask:0xf bank_mask:0xf
    v_cvt_pk_bf16_f32 v55, 0, v55
    v_mul_f32 v55, 0x3d93cd3a, v55
    v_cvt_pk_bf16_f32 v55, 0, v55
    s_mov_b32 s84, 4608
    buffer_load_dwordx4 v[92:95], v6, s[40:43], s84 offen offset:0 nt
    buffer_load_dwordx2 v[96:97], v7, s[40:43], s84 offen offset:0 nt
    s_waitcnt vmcnt(6)
    buffer_load_dwordx4 v[98:101], v6, s[48:51], 0 offen offset:0 nt
    buffer_load_dwordx2 v[102:103], v7, s[48:51], 0 offen offset:0 nt
    s_waitcnt vmcnt(6)
    buffer_load_dwordx4 v[104:107], v6, s[48:51], 0 offen offset:1536 nt
    buffer_load_dwordx2 v[108:109], v7, s[48:51], 0 offen offset:1536 nt
    s_waitcnt vmcnt(6)
    buffer_load_dwordx4 v[110:113], v6, s[48:51], 0 offen offset:3072 nt
    buffer_load_dwordx2 v[114:115], v7, s[48:51], 0 offen offset:3072 nt
    s_waitcnt vmcnt(6)
    buffer_load_dwordx4 v[116:119], v6, s[48:51], s84 offen offset:0 nt
    buffer_load_dwordx2 v[120:121], v7, s[48:51], s84 offen offset:0 nt
    v_mov_b32 v62, 0
    v_mov_b32 v63, 0
    v_mov_b32 v64, 0
    v_mov_b32 v65, 0
    v_dot2c_f32_bf16 v62, v218, v46
    v_dot2c_f32_bf16 v63, v224, v46
    v_dot2c_f32_bf16 v64, v230, v46
    v_dot2c_f32_bf16 v65, v92, v46
    v_dot2c_f32_bf16 v62, v219, v47
    v_dot2c_f32_bf16 v63, v225, v47
    v_dot2c_f32_bf16 v64, v231, v47
    v_dot2c_f32_bf16 v65, v93, v47
    v_dot2c_f32_bf16 v62, v220, v48
    v_dot2c_f32_bf16 v63, v226, v48
    v_dot2c_f32_bf16 v64, v232, v48
    v_dot2c_f32_bf16 v65, v94, v48
    v_dot2c_f32_bf16 v62, v221, v49
    v_dot2c_f32_bf16 v63, v227, v49
    v_dot2c_f32_bf16 v64, v233, v49
    v_dot2c_f32_bf16 v65, v95, v49
    v_dot2c_f32_bf16 v62, v222, v50
    v_dot2c_f32_bf16 v63, v228, v50
    v_dot2c_f32_bf16 v64, v234, v50
    v_dot2c_f32_bf16 v65, v96, v50
    v_dot2c_f32_bf16 v62, v223, v51
    v_dot2c_f32_bf16 v63, v229, v51
    v_dot2c_f32_bf16 v64, v235, v51
    v_dot2c_f32_bf16 v65, v97, v51
    v_add_f32_dpp v66, v62, v62 row_ror:8 row_mask:0xf bank_mask:0xf
    s_nop 0
    v_add_f32_dpp v67, v64, v64 row_ror:8 row_mask:0xf bank_mask:0xf
    v_add_f32_dpp v66, v63, v63 row_ror:8 row_mask:0xf bank_mask:0xc
    s_nop 0
    v_add_f32_dpp v67, v65, v65 row_ror:8 row_mask:0xf bank_mask:0xc
    v_add_f32_dpp v56, v66, v66 row_half_mirror row_mask:0xf bank_mask:0xf
    s_nop 1
    v_add_f32_dpp v56, v67, v67 row_half_mirror row_mask:0xf bank_mask:0xa
    s_nop 1
    v_add_f32_dpp v56, v56, v56 quad_perm:[2,3,0,1] row_mask:0xf bank_mask:0xf
    s_nop 1
    v_add_f32_dpp v56, v56, v56 quad_perm:[1,0,3,2] row_mask:0xf bank_mask:0xf
    v_cvt_pk_bf16_f32 v56, 0, v56
    v_mul_f32 v56, 0x3d93cd3a, v56
    v_cvt_pk_bf16_f32 v56, 0, v56
    v_max3_f32 v68, v52, v53, v54
    v_max_f32 v68, v68, v55
    v_mov_b32 v69, v56
    s_nop 0
    v_max_f32_dpp v68, v68, v68 row_ror:4 row_mask:0xf bank_mask:0xf
    v_max_f32_dpp v69, v69, v69 row_ror:4 row_mask:0xf bank_mask:0xf
    s_nop 0
    v_max_f32_dpp v68, v68, v68 row_ror:8 row_mask:0xf bank_mask:0xf
    v_max_f32_dpp v69, v69, v69 row_ror:8 row_mask:0xf bank_mask:0xf
    v_mov_b32 v70, v68
    v_mov_b32 v71, v69
    s_nop 0
    v_permlane16_swap_b32 v68, v70
    v_permlane16_swap_b32 v69, v71
    v_max_f32 v68, v68, v70
    v_max_f32 v69, v69, v71
    v_mov_b32 v70, v68
    v_mov_b32 v71, v69
    s_nop 0
    v_permlane32_swap_b32 v68, v70
    v_permlane32_swap_b32 v69, v71
    v_max_f32 v68, v68, v70
    v_max_f32 v69, v69, v71
    s_lshl_b32 s80, s76, 3
    v_mov_b32 v70, s80
    s_mov_b64 exec, 1
    ds_write_b64 v70, v[68:69] offset:19968
    s_mov_b64 exec, -1
    v_and_b32 v71, 7, v1
    v_lshlrev_b32 v71, 3, v71
    s_waitcnt lgkmcnt(0)
    s_barrier
    ds_read_b64 v[24:25], v71 offset:19968
    s_waitcnt lgkmcnt(0)
    v_max_f32_dpp v24, v24, v24 quad_perm:[1,0,3,2] row_mask:0xf bank_mask:0xf
    v_max_f32_dpp v25, v25, v25 quad_perm:[1,0,3,2] row_mask:0xf bank_mask:0xf
    s_nop 0
    v_max_f32_dpp v24, v24, v24 quad_perm:[2,3,0,1] row_mask:0xf bank_mask:0xf
    v_max_f32_dpp v25, v25, v25 quad_perm:[2,3,0,1] row_mask:0xf bank_mask:0xf
    s_nop 0
    v_max_f32_dpp v24, v24, v24 row_half_mirror row_mask:0xf bank_mask:0xf
    v_max_f32_dpp v25, v25, v25 row_half_mirror row_mask:0xf bank_mask:0xf
    s_mov_b32 s80, 0x3fb8aa3b
    v_sub_f32 v52, v52, v24
    v_sub_f32 v53, v53, v24
    v_sub_f32 v54, v54, v24
    v_sub_f32 v55, v55, v24
    v_sub_f32 v56, v56, v25
    v_mul_f32 v52, s80, v52
    v_mul_f32 v53, s80, v53
    v_mul_f32 v54, s80, v54
    v_mul_f32 v55, s80, v55
    v_mul_f32 v56, s80, v56
    v_exp_f32 v52, v52
    v_exp_f32 v53, v53
    v_exp_f32 v54, v54
    v_exp_f32 v55, v55
    v_exp_f32 v56, v56
    v_cvt_pk_bf16_f32 v52, 0, v52
    v_cvt_pk_bf16_f32 v53, 0, v53
    v_cvt_pk_bf16_f32 v54, 0, v54
    v_cvt_pk_bf16_f32 v55, 0, v55
    v_cvt_pk_bf16_f32 v56, 0, v56
    v_lshrrev_b32 v57, 16, v52
    v_lshrrev_b32 v58, 16, v53
    v_lshrrev_b32 v59, 16, v54
    v_lshrrev_b32 v60, 16, v55
    v_lshrrev_b32 v61, 16, v56
    v_add_f32 v68, v52, v53
    v_add_f32 v69, v54, v55
    v_add_f32 v68, v68, v69
    v_mov_b32 v69, v56
    s_nop 0
    v_add_f32_dpp v68, v68, v68 row_ror:4 row_mask:0xf bank_mask:0xf
    v_add_f32_dpp v69, v69, v69 row_ror:4 row_mask:0xf bank_mask:0xf
    s_nop 0
    v_add_f32_dpp v68, v68, v68 row_ror:8 row_mask:0xf bank_mask:0xf
    v_add_f32_dpp v69, v69, v69 row_ror:8 row_mask:0xf bank_mask:0xf
    v_mov_b32 v70, v68
    v_mov_b32 v71, v69
    s_nop 0
    v_permlane16_swap_b32 v68, v70
    v_permlane16_swap_b32 v69, v71
    v_add_f32 v68, v68, v70
    v_add_f32 v69, v69, v71
    v_mov_b32 v70, v68
    v_mov_b32 v71, v69
    s_nop 0
    v_permlane32_swap_b32 v68, v70
    v_permlane32_swap_b32 v69, v71
    v_add_f32 v68, v68, v70
    v_add_f32 v69, v69, v71
    v_cmp_gt_u32 vcc, 4, v1
    v_mul_f32 v70, 0x3e000000, v24
    v_mul_f32 v71, 0x3e000000, v25
    v_cndmask_b32 v68, v70, v68, vcc
    v_cndmask_b32 v69, v71, v69, vcc
    s_mul_i32 s80, s76, 800
    v_lshlrev_b32 v72, 2, v1
    v_add_u32 v72, s80, v72
    s_mov_b64 exec, 0xff
    ds_write_b32 v72, v68 offset:13568
    ds_write_b32 v72, v69 offset:7168
    s_mov_b64 exec, -1
    s_waitcnt vmcnt(6)
    buffer_load_dwordx4 v[122:125], v6, s[44:47], 0 offen offset:0 nt
    buffer_load_dwordx2 v[126:127], v7, s[44:47], 0 offen offset:0 nt
    v_dot2c_f32_bf16_dpp v28, v61, v98 row_newbcast:0 row_mask:0xf bank_mask:0xf
    v_dot2c_f32_bf16_dpp v29, v56, v98 row_newbcast:0 row_mask:0xf bank_mask:0xf
    v_dot2c_f32_bf16_dpp v30, v61, v99 row_newbcast:0 row_mask:0xf bank_mask:0xf
    v_dot2c_f32_bf16_dpp v31, v56, v99 row_newbcast:0 row_mask:0xf bank_mask:0xf
    v_dot2c_f32_bf16_dpp v32, v61, v100 row_newbcast:0 row_mask:0xf bank_mask:0xf
    v_dot2c_f32_bf16_dpp v33, v56, v100 row_newbcast:0 row_mask:0xf bank_mask:0xf
    v_dot2c_f32_bf16_dpp v34, v61, v101 row_newbcast:0 row_mask:0xf bank_mask:0xf
    v_dot2c_f32_bf16_dpp v35, v56, v101 row_newbcast:0 row_mask:0xf bank_mask:0xf
    v_dot2c_f32_bf16_dpp v36, v61, v102 row_newbcast:0 row_mask:0xf bank_mask:0xf
    v_dot2c_f32_bf16_dpp v37, v56, v102 row_newbcast:0 row_mask:0xf bank_mask:0xf
    v_dot2c_f32_bf16_dpp v38, v61, v103 row_newbcast:0 row_mask:0xf bank_mask:0xf
    v_dot2c_f32_bf16_dpp v39, v56, v103 row_newbcast:0 row_mask:0xf bank_mask:0xf
    s_waitcnt vmcnt(6)
    buffer_load_dwordx4 v[128:131], v6, s[44:47], 0 offen offset:1536 nt
    buffer_load_dwordx2 v[132:133], v7, s[44:47], 0 offen offset:1536 nt
    s_cmp_lg_u32 s76, 2
    s_cbranch_scc1 L_noaf1
    v_lshlrev_b32 v77, 2, v1
    buffer_load_dword v76, v77, s[60:63], 0 offen sc1
L_noaf1:
    v_dot2c_f32_bf16_dpp v28, v61, v104 row_newbcast:8 row_mask:0xf bank_mask:0xf
    v_dot2c_f32_bf16_dpp v29, v56, v104 row_newbcast:8 row_mask:0xf bank_mask:0xf
    v_dot2c_f32_bf16_dpp v30, v61, v105 row_newbcast:8 row_mask:0xf bank_mask:0xf
    v_dot2c_f32_bf16_dpp v31, v56, v105 row_newbcast:8 row_mask:0xf bank_mask:0xf
    v_dot2c_f32_bf16_dpp v32, v61, v106 row_newbcast:8 row_mask:0xf bank_mask:0xf
    v_dot2c_f32_bf16_dpp v33, v56, v106 row_newbcast:8 row_mask:0xf bank_mask:0xf
    v_dot2c_f32_bf16_dpp v34, v61, v107 row_newbcast:8 row_mask:0xf bank_mask:0xf
    v_dot2c_f32_bf16_dpp v35, v56, v107 row_newbcast:8 row_mask:0xf bank_mask:0xf
    v_dot2c_f32_bf16_dpp v36, v61, v108 row_newbcast:8 row_mask:0xf bank_mask:0xf
    v_dot2c_f32_bf16_dpp v37, v56, v108 row_newbcast:8 row_mask:0xf bank_mask:0xf
    v_dot2c_f32_bf16_dpp v38, v61, v109 row_newbcast:8 row_mask:0xf bank_mask:0xf
    v_dot2c_f32_bf16_dpp v39, v56, v109 row_newbcast:8 row_mask:0xf bank_mask:0xf
    s_waitcnt vmcnt(3)
    s_bitcmp1_b32 s100, 6
    s_cbranch_scc1 L_vm12
    s_waitcnt vmcnt(2)
L_vm12:
    buffer_load_dwordx4 v[134:137], v6, s[44:47], 0 offen offset:3072 nt
    buffer_load_dwordx2 v[138:139], v7, s[44:47], 0 offen offset:3072 nt
    v_dot2c_f32_bf16_dpp v28, v61, v110 row_newbcast:4 row_mask:0xf bank_mask:0xf
    v_dot2c_f32_bf16_dpp v29, v56, v110 row_newbcast:4 row_mask:0xf bank_mask:0xf
    v_dot2c_f32_bf16_dpp v30, v61, v111 row_newbcast:4 row_mask:0xf bank_mask:0xf
    v_dot2c_f32_bf16_dpp v31, v56, v111 row_newbcast:4 row_mask:0xf bank_mask:0xf
    v_dot2c_f32_bf16_dpp v32, v61, v112 row_newbcast:4 row_mask:0xf bank_mask:0xf
    v_dot2c_f32_bf16_dpp v33, v56, v112 row_newbcast:4 row_mask:0xf bank_mask:0xf
    v_dot2c_f32_bf16_dpp v34, v61, v113 row_newbcast:4 row_mask:0xf bank_mask:0xf
    v_dot2c_f32_bf16_dpp v35, v56, v113 row_newbcast:4 row_mask:0xf bank_mask:0xf
    v_dot2c_f32_bf16_dpp v36, v61, v114 row_newbcast:4 row_mask:0xf bank_mask:0xf
    v_dot2c_f32_bf16_dpp v37, v56, v114 row_newbcast:4 row_mask:0xf bank_mask:0xf
    v_dot2c_f32_bf16_dpp v38, v61, v115 row_newbcast:4 row_mask:0xf bank_mask:0xf
    v_dot2c_f32_bf16_dpp v39, v56, v115 row_newbcast:4 row_mask:0xf bank_mask:0xf
    v_dot2c_f32_bf16_dpp v28, v61, v116 row_newbcast:12 row_mask:0xf bank_mask:0xf
    v_dot2c_f32_bf16_dpp v29, v56, v116 row_newbcast:12 row_mask:0xf bank_mask:0xf
    v_dot2c_f32_bf16_dpp v30, v61, v117 row_newbcast:12 row_mask:0xf bank_mask:0xf
    v_dot2c_f32_bf16_dpp v31, v56, v117 row_newbcast:12 row_mask:0xf bank_mask:0xf
    v_dot2c_f32_bf16_dpp v32, v61, v118 row_newbcast:12 row_mask:0xf bank_mask:0xf
    v_dot2c_f32_bf16_dpp v33, v56, v118 row_newbcast:12 row_mask:0xf bank_mask:0xf
    v_dot2c_f32_bf16_dpp v34, v61, v119 row_newbcast:12 row_mask:0xf bank_mask:0xf
    v_dot2c_f32_bf16_dpp v35, v56, v119 row_newbcast:12 row_mask:0xf bank_mask:0xf
    v_dot2c_f32_bf16_dpp v36, v61, v120 row_newbcast:12 row_mask:0xf bank_mask:0xf
    v_dot2c_f32_bf16_dpp v37, v56, v120 row_newbcast:12 row_mask:0xf bank_mask:0xf
    v_dot2c_f32_bf16_dpp v38, v61, v121 row_newbcast:12 row_mask:0xf bank_mask:0xf
    v_dot2c_f32_bf16_dpp v39, v56, v121 row_newbcast:12 row_mask:0xf bank_mask:0xf
    v_permlane32_swap_b32 v28, v34
    v_permlane32_swap_b32 v29, v35
    v_permlane32_swap_b32 v30, v36
    v_permlane32_swap_b32 v31, v37
    v_permlane32_swap_b32 v32, v38
    v_permlane32_swap_b32 v33, v39
    v_add_f32 v28, v28, v34
    v_add_f32 v29, v29, v35
    v_add_f32 v30, v30, v36
    v_add_f32 v31, v31, v37
    v_add_f32 v32, v32, v38
    v_add_f32 v33, v33, v39
    v_permlane16_swap_b32 v28, v31
    v_permlane16_swap_b32 v29, v32
    v_permlane16_swap_b32 v30, v33
    v_add_f32 v28, v28, v31
    v_add_f32 v29, v29, v32
    v_add_f32 v30, v30, v33
    ds_write_b32 v8, v28 offset:6400
    ds_write_b32 v8, v29 offset:6404
    ds_write_b32 v9, v30 offset:6400
    v_mov_b32 v28, 0
    v_mov_b32 v29, 0
    v_mov_b32 v30, 0
    v_mov_b32 v31, 0
    v_mov_b32 v32, 0
    v_mov_b32 v33, 0
    v_mov_b32 v34, 0
    v_mov_b32 v35, 0
    v_mov_b32 v36, 0
    v_mov_b32 v37, 0
    v_mov_b32 v38, 0
    v_mov_b32 v39, 0
    v_mul_u32_u24 v68, 0x500, v2
    v_lshl_add_u32 v4, v3, 4, v68
    s_waitcnt vmcnt(3)
    s_bitcmp1_b32 s100, 6
    s_cbranch_scc1 L_vm13
    s_waitcnt vmcnt(2)
L_vm13:
    buffer_load_dwordx4 v[140:143], v6, s[44:47], s84 offen offset:0 nt
    buffer_load_dwordx2 v[144:145], v7, s[44:47], s84 offen offset:0 nt
    s_cmp_lg_u32 s76, 2
    s_cbranch_scc1 L_noaf2
    s_waitcnt vmcnt(4)
    v_cmp_ne_u32 vcc, 0x01010101, v76
    s_cbranch_vccz L_ok_af
    s_mov_b32 s85, 32768
L_spin_af:
    s_sleep 8
    v_lshlrev_b32 v77, 2, v1
    buffer_load_dword v76, v77, s[60:63], 0 offen sc1
    s_waitcnt vmcnt(0)
    v_cmp_ne_u32 vcc, 0x01010101, v76
    s_cbranch_vccz L_ok_af
    s_sub_u32 s85, s85, 1
    s_cmp_lg_u32 s85, 0
    s_cbranch_scc1 L_spin_af
L_ok_af:
L_noaf2:
    v_dot2c_f32_bf16_dpp v28, v57, v122 row_newbcast:0 row_mask:0xf bank_mask:0xf
    v_dot2c_f32_bf16_dpp v29, v52, v122 row_newbcast:0 row_mask:0xf bank_mask:0xf
    v_dot2c_f32_bf16_dpp v30, v57, v123 row_newbcast:0 row_mask:0xf bank_mask:0xf
    v_dot2c_f32_bf16_dpp v31, v52, v123 row_newbcast:0 row_mask:0xf bank_mask:0xf
    v_dot2c_f32_bf16_dpp v32, v57, v124 row_newbcast:0 row_mask:0xf bank_mask:0xf
    v_dot2c_f32_bf16_dpp v33, v52, v124 row_newbcast:0 row_mask:0xf bank_mask:0xf
    v_dot2c_f32_bf16_dpp v34, v57, v125 row_newbcast:0 row_mask:0xf bank_mask:0xf
    v_dot2c_f32_bf16_dpp v35, v52, v125 row_newbcast:0 row_mask:0xf bank_mask:0xf
    v_dot2c_f32_bf16_dpp v36, v57, v126 row_newbcast:0 row_mask:0xf bank_mask:0xf
    v_dot2c_f32_bf16_dpp v37, v52, v126 row_newbcast:0 row_mask:0xf bank_mask:0xf
    v_dot2c_f32_bf16_dpp v38, v57, v127 row_newbcast:0 row_mask:0xf bank_mask:0xf
    v_dot2c_f32_bf16_dpp v39, v52, v127 row_newbcast:0 row_mask:0xf bank_mask:0xf
    v_dot2c_f32_bf16_dpp v28, v57, v128 row_newbcast:8 row_mask:0xf bank_mask:0xf
    v_dot2c_f32_bf16_dpp v29, v52, v128 row_newbcast:8 row_mask:0xf bank_mask:0xf
    v_dot2c_f32_bf16_dpp v30, v57, v129 row_newbcast:8 row_mask:0xf bank_mask:0xf
    v_dot2c_f32_bf16_dpp v31, v52, v129 row_newbcast:8 row_mask:0xf bank_mask:0xf
    v_dot2c_f32_bf16_dpp v32, v57, v130 row_newbcast:8 row_mask:0xf bank_mask:0xf
    v_dot2c_f32_bf16_dpp v33, v52, v130 row_newbcast:8 row_mask:0xf bank_mask:0xf
    v_dot2c_f32_bf16_dpp v34, v57, v131 row_newbcast:8 row_mask:0xf bank_mask:0xf
    v_dot2c_f32_bf16_dpp v35, v52, v131 row_newbcast:8 row_mask:0xf bank_mask:0xf
    v_dot2c_f32_bf16_dpp v36, v57, v132 row_newbcast:8 row_mask:0xf bank_mask:0xf
    v_dot2c_f32_bf16_dpp v37, v52, v132 row_newbcast:8 row_mask:0xf bank_mask:0xf
    v_dot2c_f32_bf16_dpp v38, v57, v133 row_newbcast:8 row_mask:0xf bank_mask:0xf
    v_dot2c_f32_bf16_dpp v39, v52, v133 row_newbcast:8 row_mask:0xf bank_mask:0xf
    s_waitcnt vmcnt(2)
    buffer_load_dwordx4 v[146:149], v6, s[44:47], s84 offen offset:1536 nt
    buffer_load_dwordx2 v[150:151], v7, s[44:47], s84 offen offset:1536 nt
    v_dot2c_f32_bf16_dpp v28, v57, v134 row_newbcast:4 row_mask:0xf bank_mask:0xf
    v_dot2c_f32_bf16_dpp v29, v52, v134 row_newbcast:4 row_mask:0xf bank_mask:0xf
    v_dot2c_f32_bf16_dpp v30, v57, v135 row_newbcast:4 row_mask:0xf bank_mask:0xf
    v_dot2c_f32_bf16_dpp v31, v52, v135 row_newbcast:4 row_mask:0xf bank_mask:0xf
    v_dot2c_f32_bf16_dpp v32, v57, v136 row_newbcast:4 row_mask:0xf bank_mask:0xf
    v_dot2c_f32_bf16_dpp v33, v52, v136 row_newbcast:4 row_mask:0xf bank_mask:0xf
    v_dot2c_f32_bf16_dpp v34, v57, v137 row_newbcast:4 row_mask:0xf bank_mask:0xf
    v_dot2c_f32_bf16_dpp v35, v52, v137 row_newbcast:4 row_mask:0xf bank_mask:0xf
    v_dot2c_f32_bf16_dpp v36, v57, v138 row_newbcast:4 row_mask:0xf bank_mask:0xf
    v_dot2c_f32_bf16_dpp v37, v52, v138 row_newbcast:4 row_mask:0xf bank_mask:0xf
    v_dot2c_f32_bf16_dpp v38, v57, v139 row_newbcast:4 row_mask:0xf bank_mask:0xf
    v_dot2c_f32_bf16_dpp v39, v52, v139 row_newbcast:4 row_mask:0xf bank_mask:0xf
    s_waitcnt vmcnt(2)
    buffer_load_dwordx4 v[152:155], v6, s[44:47], s84 offen offset:3072 nt
    buffer_load_dwordx2 v[156:157], v7, s[44:47], s84 offen offset:3072 nt
    v_dot2c_f32_bf16_dpp v28, v57, v140 row_newbcast:12 row_mask:0xf bank_mask:0xf
    v_dot2c_f32_bf16_dpp v29, v52, v140 row_newbcast:12 row_mask:0xf bank_mask:0xf
    v_dot2c_f32_bf16_dpp v30, v57, v141 row_newbcast:12 row_mask:0xf bank_mask:0xf
    v_dot2c_f32_bf16_dpp v31, v52, v141 row_newbcast:12 row_mask:0xf bank_mask:0xf
    v_dot2c_f32_bf16_dpp v32, v57, v142 row_newbcast:12 row_mask:0xf bank_mask:0xf
    v_dot2c_f32_bf16_dpp v33, v52, v142 row_newbcast:12 row_mask:0xf bank_mask:0xf
    v_dot2c_f32_bf16_dpp v34, v57, v143 row_newbcast:12 row_mask:0xf bank_mask:0xf
    v_dot2c_f32_bf16_dpp v35, v52, v143 row_newbcast:12 row_mask:0xf bank_mask:0xf
    v_dot2c_f32_bf16_dpp v36, v57, v144 row_newbcast:12 row_mask:0xf bank_mask:0xf
    v_dot2c_f32_bf16_dpp v37, v52, v144 row_newbcast:12 row_mask:0xf bank_mask:0xf
    v_dot2c_f32_bf16_dpp v38, v57, v145 row_newbcast:12 row_mask:0xf bank_mask:0xf
    v_dot2c_f32_bf16_dpp v39, v52, v145 row_newbcast:12 row_mask:0xf bank_mask:0xf
    s_waitcnt vmcnt(2)
    s_mov_b32 s84, 9216
    buffer_load_dwordx4 v[158:161], v6, s[44:47], s84 offen offset:0 nt
    buffer_load_dwordx2 v[162:163], v7, s[44:47], s84 offen offset:0 nt
    v_dot2c_f32_bf16_dpp v28, v58, v146 row_newbcast:0 row_mask:0xf bank_mask:0xf
    v_dot2c_f32_bf16_dpp v29, v53, v146 row_newbcast:0 row_mask:0xf bank_mask:0xf
    v_dot2c_f32_bf16_dpp v30, v58, v147 row_newbcast:0 row_mask:0xf bank_mask:0xf
    v_dot2c_f32_bf16_dpp v31, v53, v147 row_newbcast:0 row_mask:0xf bank_mask:0xf
    v_dot2c_f32_bf16_dpp v32, v58, v148 row_newbcast:0 row_mask:0xf bank_mask:0xf
    v_dot2c_f32_bf16_dpp v33, v53, v148 row_newbcast:0 row_mask:0xf bank_mask:0xf
    v_dot2c_f32_bf16_dpp v34, v58, v149 row_newbcast:0 row_mask:0xf bank_mask:0xf
    v_dot2c_f32_bf16_dpp v35, v53, v149 row_newbcast:0 row_mask:0xf bank_mask:0xf
    v_dot2c_f32_bf16_dpp v36, v58, v150 row_newbcast:0 row_mask:0xf bank_mask:0xf
    v_dot2c_f32_bf16_dpp v37, v53, v150 row_newbcast:0 row_mask:0xf bank_mask:0xf
    v_dot2c_f32_bf16_dpp v38, v58, v151 row_newbcast:0 row_mask:0xf bank_mask:0xf
    v_dot2c_f32_bf16_dpp v39, v53, v151 row_newbcast:0 row_mask:0xf bank_mask:0xf
    s_waitcnt vmcnt(2)
    buffer_load_dwordx4 v[164:167], v6, s[44:47], s84 offen offset:1536 nt
    buffer_load_dwordx2 v[168:169], v7, s[44:47], s84 offen offset:1536 nt
    v_dot2c_f32_bf16_dpp v28, v58, v152 row_newbcast:8 row_mask:0xf bank_mask:0xf
    v_dot2c_f32_bf16_dpp v29, v53, v152 row_newbcast:8 row_mask:0xf bank_mask:0xf
    v_dot2c_f32_bf16_dpp v30, v58, v153 row_newbcast:8 row_mask:0xf bank_mask:0xf
    v_dot2c_f32_bf16_dpp v31, v53, v153 row_newbcast:8 row_mask:0xf bank_mask:0xf
    v_dot2c_f32_bf16_dpp v32, v58, v154 row_newbcast:8 row_mask:0xf bank_mask:0xf
    v_dot2c_f32_bf16_dpp v33, v53, v154 row_newbcast:8 row_mask:0xf bank_mask:0xf
    v_dot2c_f32_bf16_dpp v34, v58, v155 row_newbcast:8 row_mask:0xf bank_mask:0xf
    v_dot2c_f32_bf16_dpp v35, v53, v155 row_newbcast:8 row_mask:0xf bank_mask:0xf
    v_dot2c_f32_bf16_dpp v36, v58, v156 row_newbcast:8 row_mask:0xf bank_mask:0xf
    v_dot2c_f32_bf16_dpp v37, v53, v156 row_newbcast:8 row_mask:0xf bank_mask:0xf
    v_dot2c_f32_bf16_dpp v38, v58, v157 row_newbcast:8 row_mask:0xf bank_mask:0xf
    v_dot2c_f32_bf16_dpp v39, v53, v157 row_newbcast:8 row_mask:0xf bank_mask:0xf
    s_waitcnt vmcnt(2)
    buffer_load_dwordx4 v[170:173], v6, s[44:47], s84 offen offset:3072 nt
    buffer_load_dwordx2 v[174:175], v7, s[44:47], s84 offen offset:3072 nt
    v_dot2c_f32_bf16_dpp v28, v58, v158 row_newbcast:4 row_mask:0xf bank_mask:0xf
    v_dot2c_f32_bf16_dpp v29, v53, v158 row_newbcast:4 row_mask:0xf bank_mask:0xf
    v_dot2c_f32_bf16_dpp v30, v58, v159 row_newbcast:4 row_mask:0xf bank_mask:0xf
    v_dot2c_f32_bf16_dpp v31, v53, v159 row_newbcast:4 row_mask:0xf bank_mask:0xf
    v_dot2c_f32_bf16_dpp v32, v58, v160 row_newbcast:4 row_mask:0xf bank_mask:0xf
    v_dot2c_f32_bf16_dpp v33, v53, v160 row_newbcast:4 row_mask:0xf bank_mask:0xf
    v_dot2c_f32_bf16_dpp v34, v58, v161 row_newbcast:4 row_mask:0xf bank_mask:0xf
    v_dot2c_f32_bf16_dpp v35, v53, v161 row_newbcast:4 row_mask:0xf bank_mask:0xf
    v_dot2c_f32_bf16_dpp v36, v58, v162 row_newbcast:4 row_mask:0xf bank_mask:0xf
    v_dot2c_f32_bf16_dpp v37, v53, v162 row_newbcast:4 row_mask:0xf bank_mask:0xf
    v_dot2c_f32_bf16_dpp v38, v58, v163 row_newbcast:4 row_mask:0xf bank_mask:0xf
    v_dot2c_f32_bf16_dpp v39, v53, v163 row_newbcast:4 row_mask:0xf bank_mask:0xf
    s_waitcnt vmcnt(2)
    s_mov_b32 s84, 13824
    buffer_load_dwordx4 v[176:179], v6, s[44:47], s84 offen offset:0 nt
    buffer_load_dwordx2 v[180:181], v7, s[44:47], s84 offen offset:0 nt
    v_dot2c_f32_bf16_dpp v28, v58, v164 row_newbcast:12 row_mask:0xf bank_mask:0xf
    v_dot2c_f32_bf16_dpp v29, v53, v164 row_newbcast:12 row_mask:0xf bank_mask:0xf
    v_dot2c_f32_bf16_dpp v30, v58, v165 row_newbcast:12 row_mask:0xf bank_mask:0xf
    v_dot2c_f32_bf16_dpp v31, v53, v165 row_newbcast:12 row_mask:0xf bank_mask:0xf
    v_dot2c_f32_bf16_dpp v32, v58, v166 row_newbcast:12 row_mask:0xf bank_mask:0xf
    v_dot2c_f32_bf16_dpp v33, v53, v166 row_newbcast:12 row_mask:0xf bank_mask:0xf
    v_dot2c_f32_bf16_dpp v34, v58, v167 row_newbcast:12 row_mask:0xf bank_mask:0xf
    v_dot2c_f32_bf16_dpp v35, v53, v167 row_newbcast:12 row_mask:0xf bank_mask:0xf
    v_dot2c_f32_bf16_dpp v36, v58, v168 row_newbcast:12 row_mask:0xf bank_mask:0xf
    v_dot2c_f32_bf16_dpp v37, v53, v168 row_newbcast:12 row_mask:0xf bank_mask:0xf
    v_dot2c_f32_bf16_dpp v38, v58, v169 row_newbcast:12 row_mask:0xf bank_mask:0xf
    v_dot2c_f32_bf16_dpp v39, v53, v169 row_newbcast:12 row_mask:0xf bank_mask:0xf
    s_waitcnt vmcnt(2)
    buffer_load_dwordx4 v[182:185], v6, s[44:47], s84 offen offset:1536 nt
    buffer_load_dwordx2 v[186:187], v7, s[44:47], s84 offen offset:1536 nt
    v_dot2c_f32_bf16_dpp v28, v59, v170 row_newbcast:0 row_mask:0xf bank_mask:0xf
    v_dot2c_f32_bf16_dpp v29, v54, v170 row_newbcast:0 row_mask:0xf bank_mask:0xf
    v_dot2c_f32_bf16_dpp v30, v59, v171 row_newbcast:0 row_mask:0xf bank_mask:0xf
    v_dot2c_f32_bf16_dpp v31, v54, v171 row_newbcast:0 row_mask:0xf bank_mask:0xf
    v_dot2c_f32_bf16_dpp v32, v59, v172 row_newbcast:0 row_mask:0xf bank_mask:0xf
    v_dot2c_f32_bf16_dpp v33, v54, v172 row_newbcast:0 row_mask:0xf bank_mask:0xf
    v_dot2c_f32_bf16_dpp v34, v59, v173 row_newbcast:0 row_mask:0xf bank_mask:0xf
    v_dot2c_f32_bf16_dpp v35, v54, v173 row_newbcast:0 row_mask:0xf bank_mask:0xf
    v_dot2c_f32_bf16_dpp v36, v59, v174 row_newbcast:0 row_mask:0xf bank_mask:0xf
    v_dot2c_f32_bf16_dpp v37, v54, v174 row_newbcast:0 row_mask:0xf bank_mask:0xf
    v_dot2c_f32_bf16_dpp v38, v59, v175 row_newbcast:0 row_mask:0xf bank_mask:0xf
    v_dot2c_f32_bf16_dpp v39, v54, v175 row_newbcast:0 row_mask:0xf bank_mask:0xf
    s_waitcnt vmcnt(2)
    buffer_load_dwordx4 v[188:191], v6, s[44:47], s84 offen offset:3072 nt
    buffer_load_dwordx2 v[192:193], v7, s[44:47], s84 offen offset:3072 nt
    s_cmp_lg_u32 s76, 2
    s_cbranch_scc1 L_nork1
    v_mov_b32 v78, 1
    s_mov_b64 exec, 1
    buffer_atomic_add v78, off, s[56:59], s96 sc0 sc1
    s_mov_b64 exec, -1
L_nork1:
    v_dot2c_f32_bf16_dpp v28, v59, v176 row_newbcast:8 row_mask:0xf bank_mask:0xf
    v_dot2c_f32_bf16_dpp v29, v54, v176 row_newbcast:8 row_mask:0xf bank_mask:0xf
    v_dot2c_f32_bf16_dpp v30, v59, v177 row_newbcast:8 row_mask:0xf bank_mask:0xf
    v_dot2c_f32_bf16_dpp v31, v54, v177 row_newbcast:8 row_mask:0xf bank_mask:0xf
    v_dot2c_f32_bf16_dpp v32, v59, v178 row_newbcast:8 row_mask:0xf bank_mask:0xf
    v_dot2c_f32_bf16_dpp v33, v54, v178 row_newbcast:8 row_mask:0xf bank_mask:0xf
    v_dot2c_f32_bf16_dpp v34, v59, v179 row_newbcast:8 row_mask:0xf bank_mask:0xf
    v_dot2c_f32_bf16_dpp v35, v54, v179 row_newbcast:8 row_mask:0xf bank_mask:0xf
    v_dot2c_f32_bf16_dpp v36, v59, v180 row_newbcast:8 row_mask:0xf bank_mask:0xf
    v_dot2c_f32_bf16_dpp v37, v54, v180 row_newbcast:8 row_mask:0xf bank_mask:0xf
    v_dot2c_f32_bf16_dpp v38, v59, v181 row_newbcast:8 row_mask:0xf bank_mask:0xf
    v_dot2c_f32_bf16_dpp v39, v54, v181 row_newbcast:8 row_mask:0xf bank_mask:0xf
    s_waitcnt vmcnt(3)
    s_bitcmp1_b32 s100, 6
    s_cbranch_scc1 L_vm14
    s_waitcnt vmcnt(2)
L_vm14:
    s_mov_b32 s84, 18432
    buffer_load_dwordx4 v[194:197], v6, s[44:47], s84 offen offset:0 nt
    buffer_load_dwordx2 v[198:199], v7, s[44:47], s84 offen offset:0 nt
    v_dot2c_f32_bf16_dpp v28, v59, v182 row_newbcast:4 row_mask:0xf bank_mask:0xf
    v_dot2c_f32_bf16_dpp v29, v54, v182 row_newbcast:4 row_mask:0xf bank_mask:0xf
    v_dot2c_f32_bf16_dpp v30, v59, v183 row_newbcast:4 row_mask:0xf bank_mask:0xf
    v_dot2c_f32_bf16_dpp v31, v54, v183 row_newbcast:4 row_mask:0xf bank_mask:0xf
    v_dot2c_f32_bf16_dpp v32, v59, v184 row_newbcast:4 row_mask:0xf bank_mask:0xf
    v_dot2c_f32_bf16_dpp v33, v54, v184 row_newbcast:4 row_mask:0xf bank_mask:0xf
    v_dot2c_f32_bf16_dpp v34, v59, v185 row_newbcast:4 row_mask:0xf bank_mask:0xf
    v_dot2c_f32_bf16_dpp v35, v54, v185 row_newbcast:4 row_mask:0xf bank_mask:0xf
    v_dot2c_f32_bf16_dpp v36, v59, v186 row_newbcast:4 row_mask:0xf bank_mask:0xf
    v_dot2c_f32_bf16_dpp v37, v54, v186 row_newbcast:4 row_mask:0xf bank_mask:0xf
    v_dot2c_f32_bf16_dpp v38, v59, v187 row_newbcast:4 row_mask:0xf bank_mask:0xf
    v_dot2c_f32_bf16_dpp v39, v54, v187 row_newbcast:4 row_mask:0xf bank_mask:0xf
    s_waitcnt vmcnt(3)
    s_bitcmp1_b32 s100, 6
    s_cbranch_scc1 L_vm15
    s_waitcnt vmcnt(2)
L_vm15:
    buffer_load_dwordx4 v[200:203], v6, s[44:47], s84 offen offset:1536 nt
    buffer_load_dwordx2 v[204:205], v7, s[44:47], s84 offen offset:1536 nt
    v_dot2c_f32_bf16_dpp v28, v59, v188 row_newbcast:12 row_mask:0xf bank_mask:0xf
    v_dot2c_f32_bf16_dpp v29, v54, v188 row_newbcast:12 row_mask:0xf bank_mask:0xf
    v_dot2c_f32_bf16_dpp v30, v59, v189 row_newbcast:12 row_mask:0xf bank_mask:0xf
    v_dot2c_f32_bf16_dpp v31, v54, v189 row_newbcast:12 row_mask:0xf bank_mask:0xf
    v_dot2c_f32_bf16_dpp v32, v59, v190 row_newbcast:12 row_mask:0xf bank_mask:0xf
    v_dot2c_f32_bf16_dpp v33, v54, v190 row_newbcast:12 row_mask:0xf bank_mask:0xf
    v_dot2c_f32_bf16_dpp v34, v59, v191 row_newbcast:12 row_mask:0xf bank_mask:0xf
    v_dot2c_f32_bf16_dpp v35, v54, v191 row_newbcast:12 row_mask:0xf bank_mask:0xf
    v_dot2c_f32_bf16_dpp v36, v59, v192 row_newbcast:12 row_mask:0xf bank_mask:0xf
    v_dot2c_f32_bf16_dpp v37, v54, v192 row_newbcast:12 row_mask:0xf bank_mask:0xf
    v_dot2c_f32_bf16_dpp v38, v59, v193 row_newbcast:12 row_mask:0xf bank_mask:0xf
    v_dot2c_f32_bf16_dpp v39, v54, v193 row_newbcast:12 row_mask:0xf bank_mask:0xf
    s_waitcnt vmcnt(2)
    buffer_load_dwordx4 v[206:209], v6, s[44:47], s84 offen offset:3072 nt
    buffer_load_dwordx2 v[210:211], v7, s[44:47], s84 offen offset:3072 nt
    s_cmp_lg_u32 s76, 2
    s_cbranch_scc1 L_nork2
    s_waitcnt vmcnt(6)
    v_mov_b32 v68, 0
    s_mov_b64 exec, 1
    ds_write_b32 v68, v78 offset:28288
    s_mov_b64 exec, -1
L_nork2:
    v_dot2c_f32_bf16_dpp v28, v60, v194 row_newbcast:0 row_mask:0xf bank_mask:0xf
    v_dot2c_f32_bf16_dpp v29, v55, v194 row_newbcast:0 row_mask:0xf bank_mask:0xf
    v_dot2c_f32_bf16_dpp v30, v60, v195 row_newbcast:0 row_mask:0xf bank_mask:0xf
    v_dot2c_f32_bf16_dpp v31, v55, v195 row_newbcast:0 row_mask:0xf bank_mask:0xf
    v_dot2c_f32_bf16_dpp v32, v60, v196 row_newbcast:0 row_mask:0xf bank_mask:0xf
    v_dot2c_f32_bf16_dpp v33, v55, v196 row_newbcast:0 row_mask:0xf bank_mask:0xf
    v_dot2c_f32_bf16_dpp v34, v60, v197 row_newbcast:0 row_mask:0xf bank_mask:0xf
    v_dot2c_f32_bf16_dpp v35, v55, v197 row_newbcast:0 row_mask:0xf bank_mask:0xf
    v_dot2c_f32_bf16_dpp v36, v60, v198 row_newbcast:0 row_mask:0xf bank_mask:0xf
    v_dot2c_f32_bf16_dpp v37, v55, v198 row_newbcast:0 row_mask:0xf bank_mask:0xf
    v_dot2c_f32_bf16_dpp v38, v60, v199 row_newbcast:0 row_mask:0xf bank_mask:0xf
    v_dot2c_f32_bf16_dpp v39, v55, v199 row_newbcast:0 row_mask:0xf bank_mask:0xf
    s_waitcnt vmcnt(2)
    s_mov_b32 s84, 23040
    buffer_load_dwordx4 v[212:215], v6, s[44:47], s84 offen offset:0 nt
    buffer_load_dwordx2 v[216:217], v7, s[44:47], s84 offen offset:0 nt
    v_mov_b32 v69, 0
    s_mov_b32 s85, 65536
L_rk:
    ds_read_b32 v68, v69 offset:28288
    s_waitcnt lgkmcnt(0)
    v_readfirstlane_b32 s93, v68
    s_cmp_lg_u32 s93, -1
    s_cbranch_scc1 L_rkok
    s_sub_u32 s85, s85, 1
    s_cmp_lg_u32 s85, 0
    s_cbranch_scc1 L_rk
L_rkok:
    s_min_u32 s93, s93, 63
    s_lshr_b32 s80, s93, 1
    s_and_b32 s81, s93, 1
    s_sub_u32 s82, s93, 32
    s_cmp_ge_u32 s93, 32
    s_cselect_b32 s80, s82, s80
    s_cselect_b32 s81, 2, s81
    s_cselect_b32 s83, 0x40000000, 0
    s_cselect_b32 s82, 32, 64
    v_add_u32 v5, s83, v4
    v_lshlrev_b32 v68, 10, v1
    v_mov_b32 v69, 0x40000000
    v_cmp_gt_u32 vcc, s82, v1
    s_nop 1
    v_cndmask_b32 v15, v69, v68, vcc
    s_cmp_ge_u32 s93, 48
    s_cselect_b32 s83, 0x40000000, 0
    v_add_u32 v4, s83, v4
    s_and_b32 s80, s80, 15
    s_lshl_b32 s80, s80, 1
    s_bfe_u32 s82, s2, 0x10003
    s_add_u32 s80, s80, s82
    s_mul_i32 s97, s80, 245760
    s_mul_i32 s82, s76, 30720
    s_add_u32 s97, s97, s82
    s_lshl_b32 s82, s81, 9
    s_add_u32 s97, s97, s82
    s_lshl_b32 s82, s80, 14
    s_add_u32 s89, s89, s82
    s_lshl_b32 s88, s80, 4
    s_lshl_b32 s81, s81, 16
    s_add_u32 s88, s88, s81
    s_lshr_b32 s82, s2, 7
    s_lshl_b32 s82, s82, 9
    s_sub_u32 s88, s88, s82
    s_add_u32 s88, s88, 0xc0200
    v_dot2c_f32_bf16_dpp v28, v60, v200 row_newbcast:8 row_mask:0xf bank_mask:0xf
    v_dot2c_f32_bf16_dpp v29, v55, v200 row_newbcast:8 row_mask:0xf bank_mask:0xf
    v_dot2c_f32_bf16_dpp v30, v60, v201 row_newbcast:8 row_mask:0xf bank_mask:0xf
    v_dot2c_f32_bf16_dpp v31, v55, v201 row_newbcast:8 row_mask:0xf bank_mask:0xf
    v_dot2c_f32_bf16_dpp v32, v60, v202 row_newbcast:8 row_mask:0xf bank_mask:0xf
    v_dot2c_f32_bf16_dpp v33, v55, v202 row_newbcast:8 row_mask:0xf bank_mask:0xf
    v_dot2c_f32_bf16_dpp v34, v60, v203 row_newbcast:8 row_mask:0xf bank_mask:0xf
    v_dot2c_f32_bf16_dpp v35, v55, v203 row_newbcast:8 row_mask:0xf bank_mask:0xf
    v_dot2c_f32_bf16_dpp v36, v60, v204 row_newbcast:8 row_mask:0xf bank_mask:0xf
    v_dot2c_f32_bf16_dpp v37, v55, v204 row_newbcast:8 row_mask:0xf bank_mask:0xf
    v_dot2c_f32_bf16_dpp v38, v60, v205 row_newbcast:8 row_mask:0xf bank_mask:0xf
    v_dot2c_f32_bf16_dpp v39, v55, v205 row_newbcast:8 row_mask:0xf bank_mask:0xf
    s_waitcnt vmcnt(2)
    s_add_u32 s84, s97, 0
    buffer_load_dwordx4 v[218:221], v4, s[52:55], s84 offen nt
    v_dot2c_f32_bf16_dpp v28, v60, v206 row_newbcast:4 row_mask:0xf bank_mask:0xf
    v_dot2c_f32_bf16_dpp v29, v55, v206 row_newbcast:4 row_mask:0xf bank_mask:0xf
    v_dot2c_f32_bf16_dpp v30, v60, v207 row_newbcast:4 row_mask:0xf bank_mask:0xf
    v_dot2c_f32_bf16_dpp v31, v55, v207 row_newbcast:4 row_mask:0xf bank_mask:0xf
    v_dot2c_f32_bf16_dpp v32, v60, v208 row_newbcast:4 row_mask:0xf bank_mask:0xf
    v_dot2c_f32_bf16_dpp v33, v55, v208 row_newbcast:4 row_mask:0xf bank_mask:0xf
    v_dot2c_f32_bf16_dpp v34, v60, v209 row_newbcast:4 row_mask:0xf bank_mask:0xf
    v_dot2c_f32_bf16_dpp v35, v55, v209 row_newbcast:4 row_mask:0xf bank_mask:0xf
    v_dot2c_f32_bf16_dpp v36, v60, v210 row_newbcast:4 row_mask:0xf bank_mask:0xf
    v_dot2c_f32_bf16_dpp v37, v55, v210 row_newbcast:4 row_mask:0xf bank_mask:0xf
    v_dot2c_f32_bf16_dpp v38, v60, v211 row_newbcast:4 row_mask:0xf bank_mask:0xf
    v_dot2c_f32_bf16_dpp v39, v55, v211 row_newbcast:4 row_mask:0xf bank_mask:0xf
    s_waitcnt vmcnt(1)
    s_add_u32 s84, s97, 5120
    buffer_load_dwordx4 v[224:227], v4, s[52:55], s84 offen nt
    v_dot2c_f32_bf16_dpp v28, v60, v212 row_newbcast:12 row_mask:0xf bank_mask:0xf
    v_dot2c_f32_bf16_dpp v29, v55, v212 row_newbcast:12 row_mask:0xf bank_mask:0xf
    v_dot2c_f32_bf16_dpp v30, v60, v213 row_newbcast:12 row_mask:0xf bank_mask:0xf
    v_dot2c_f32_bf16_dpp v31, v55, v213 row_newbcast:12 row_mask:0xf bank_mask:0xf
    v_dot2c_f32_bf16_dpp v32, v60, v214 row_newbcast:12 row_mask:0xf bank_mask:0xf
    v_dot2c_f32_bf16_dpp v33, v55, v214 row_newbcast:12 row_mask:0xf bank_mask:0xf
    v_dot2c_f32_bf16_dpp v34, v60, v215 row_newbcast:12 row_mask:0xf bank_mask:0xf
    v_dot2c_f32_bf16_dpp v35, v55, v215 row_newbcast:12 row_mask:0xf bank_mask:0xf
    v_dot2c_f32_bf16_dpp v36, v60, v216 row_newbcast:12 row_mask:0xf bank_mask:0xf
    v_dot2c_f32_bf16_dpp v37, v55, v216 row_newbcast:12 row_mask:0xf bank_mask:0xf
    v_dot2c_f32_bf16_dpp v38, v60, v217 row_newbcast:12 row_mask:0xf bank_mask:0xf
    v_dot2c_f32_bf16_dpp v39, v55, v217 row_newbcast:12 row_mask:0xf bank_mask:0xf
    v_permlane32_swap_b32 v28, v34
    v_permlane32_swap_b32 v29, v35
    v_permlane32_swap_b32 v30, v36
    v_permlane32_swap_b32 v31, v37
    v_permlane32_swap_b32 v32, v38
    v_permlane32_swap_b32 v33, v39
    v_add_f32 v28, v28, v34
    v_add_f32 v29, v29, v35
    v_add_f32 v30, v30, v36
    v_add_f32 v31, v31, v37
    v_add_f32 v32, v32, v38
    v_add_f32 v33, v33, v39
    v_permlane16_swap_b32 v28, v31
    v_permlane16_swap_b32 v29, v32
    v_permlane16_swap_b32 v30, v33
    v_add_f32 v28, v28, v31
    v_add_f32 v29, v29, v32
    v_add_f32 v30, v30, v33
    ds_write_b32 v8, v28 offset:12800
    ds_write_b32 v8, v29 offset:12804
    ds_write_b32 v9, v30 offset:12800
    v_mov_b32 v28, 0
    v_mov_b32 v29, 0
    v_mov_b32 v30, 0
    v_mov_b32 v31, 0
    v_mov_b32 v32, 0
    v_mov_b32 v33, 0
    v_mov_b32 v34, 0
    v_mov_b32 v35, 0
    v_and_b32 v68, 1, v3
    v_mov_b32 v69, 0xffff
    v_mov_b32 v70, 0xffff0000
    v_cmp_eq_u32 vcc, 0, v68
    v_bfe_u32 v71, v3, 1, 2
    s_nop 0
    v_cndmask_b32 v68, v70, v69, vcc
    v_cmp_eq_u32 vcc, 0, v71
    s_nop 1
    v_cndmask_b32 v36, 0, v68, vcc
    v_cmp_eq_u32 vcc, 1, v71
    s_nop 1
    v_cndmask_b32 v37, 0, v68, vcc
    v_cmp_eq_u32 vcc, 2, v71
    s_nop 1
    v_cndmask_b32 v38, 0, v68, vcc
    v_cmp_eq_u32 vcc, 3, v71
    s_nop 1
    v_cndmask_b32 v39, 0, v68, vcc
    s_waitcnt lgkmcnt(0)
    s_barrier
    s_cmp_ge_u32 s76, 2
    s_cbranch_scc1 L_nopub1
    ds_read_b128 v[122:125], v11 offset:0
    ds_read_b128 v[126:129], v11 offset:800
    ds_read_b128 v[130:133], v11 offset:1600
    ds_read_b128 v[134:137], v11 offset:2400
    ds_read_b128 v[138:141], v11 offset:3200
    ds_read_b128 v[142:145], v11 offset:4000
    ds_read_b128 v[146:149], v11 offset:4800
    ds_read_b128 v[150:153], v11 offset:5600
    s_waitcnt lgkmcnt(6)
    v_pk_add_f32 v[122:123], v[122:123], v[126:127]
    v_pk_add_f32 v[124:125], v[124:125], v[128:129]
    s_waitcnt lgkmcnt(4)
    v_pk_add_f32 v[130:131], v[130:131], v[134:135]
    v_pk_add_f32 v[132:133], v[132:133], v[136:137]
    s_waitcnt lgkmcnt(2)
    v_pk_add_f32 v[138:139], v[138:139], v[142:143]
    v_pk_add_f32 v[140:141], v[140:141], v[144:145]
    v_pk_add_f32 v[122:123], v[122:123], v[130:131]
    v_pk_add_f32 v[124:125], v[124:125], v[132:133]
    s_waitcnt lgkmcnt(0)
    v_pk_add_f32 v[146:147], v[146:147], v[150:151]
    v_pk_add_f32 v[148:149], v[148:149], v[152:153]
    v_pk_add_f32 v[138:139], v[138:139], v[146:147]
    v_pk_add_f32 v[140:141], v[140:141], v[148:149]
    v_pk_add_f32 v[122:123], v[122:123], v[138:139]
    v_pk_add_f32 v[124:125], v[124:125], v[140:141]
    buffer_store_dwordx4 v[122:125], v14, s[56:59], s87 offen sc1
L_nopub1:
    s_cmp_ge_u32 s93, 48
    s_cbranch_scc1 L_none
    s_add_u32 s84, s97, 10240
    buffer_load_dwordx4 v[230:233], v4, s[52:55], s84 offen nt
    s_waitcnt vmcnt(3)
    s_and_b32 s101, s100, 7
    s_cbranch_scc1 L_vm16
    s_waitcnt vmcnt(2)
L_vm16:
    s_add_u32 s84, s97, 15360
    buffer_load_dwordx4 v[92:95], v4, s[52:55], s84 offen nt
    s_waitcnt vmcnt(3)
    s_and_b32 s101, s100, 7
    s_cbranch_scc1 L_vm17
    s_waitcnt vmcnt(2)
L_vm17:
    s_add_u32 s84, s97, 20480
    buffer_load_dwordx4 v[98:101], v4, s[52:55], s84 offen nt
    s_waitcnt vmcnt(2)
    s_add_u32 s84, s97, 25600
    buffer_load_dwordx4 v[104:107], v4, s[52:55], s84 offen nt
    s_cmp_ge_u32 s93, 32
    s_cbranch_scc1 L_skiph1
    s_waitcnt vmcnt(2)
    s_add_u32 s84, s97, 256
    buffer_load_dwordx4 v[110:113], v5, s[52:55], s84 offen nt
    s_waitcnt vmcnt(2)
    s_add_u32 s84, s97, 5376
    buffer_load_dwordx4 v[116:119], v5, s[52:55], s84 offen nt
    s_waitcnt vmcnt(2)
    s_add_u32 s84, s97, 10496
    buffer_load_dwordx4 v[158:161], v5, s[52:55], s84 offen nt
    s_waitcnt vmcnt(2)
    s_add_u32 s84, s97, 15616
    buffer_load_dwordx4 v[164:167], v5, s[52:55], s84 offen nt
    s_waitcnt vmcnt(2)
    s_add_u32 s84, s97, 20736
    buffer_load_dwordx4 v[170:173], v5, s[52:55], s84 offen nt
    s_waitcnt vmcnt(2)
    s_add_u32 s84, s97, 25856
    buffer_load_dwordx4 v[176:179], v5, s[52:55], s84 offen nt
L_skiph1:
    buffer_load_dwordx4 v[76:79], v12, s[56:59], s89 offen sc1
    s_waitcnt vmcnt(0)
    v_max3_u32 v68, v76, v77, v78
    v_max_u32 v68, v68, v79
    v_cmp_eq_u32 vcc, -1, v68
    s_cbranch_vccz L_ok_p1
    s_mov_b32 s85, 32768
L_spin_p1:
    s_mov_b64 exec, vcc
    buffer_load_dwordx4 v[76:79], v12, s[56:59], s89 offen sc1
    s_mov_b64 exec, -1
    s_waitcnt vmcnt(0)
    v_max3_u32 v68, v76, v77, v78
    v_max_u32 v68, v68, v79
    v_cmp_eq_u32 vcc, -1, v68
    s_cbranch_vccz L_ok_p1
    s_sub_u32 s85, s85, 1
    s_cmp_lg_u32 s85, 0
    s_cbranch_scc1 L_spin_p1
L_ok_p1:
    v_mov_b32_dpp v68, v76 row_newbcast:7 row_mask:0xf bank_mask:0x3
    s_nop 1
    v_mov_b32_dpp v68, v76 row_newbcast:15 row_mask:0xf bank_mask:0xc
    s_nop 1
    v_max_f32_dpp v69, v68, v68 row_ror:8 row_mask:0xf bank_mask:0xf
    v_mov_b32 v70, v69
    s_nop 1
    v_permlane16_swap_b32 v69, v70
    v_max_f32 v69, v69, v70
    v_mov_b32 v70, v69
    s_nop 1
    v_permlane32_swap_b32 v69, v70
    v_max_f32 v69, v69, v70
    v_sub_f32 v68, v68, v69
    v_mul_f32 v68, 0x3fb8aa3b, v68
    v_exp_f32 v68, v68
    s_nop 0
    v_mul_f32 v76, v76, v68
    v_mul_f32 v77, v77, v68
    v_mul_f32 v78, v78, v68
    v_mul_f32 v79, v79, v68
    s_nop 0
    v_permlane32_swap_b32 v76, v78
    v_permlane32_swap_b32 v77, v79
    v_add_f32 v76, v76, v78
    v_add_f32 v77, v77, v79
    s_nop 1
    v_permlane16_swap_b32 v76, v77
    v_add_f32 v76, v76, v77
    s_nop 1
    v_add_f32_dpp v76, v76, v76 row_ror:8 row_mask:0xf bank_mask:0xf
    s_nop 1
    v_rcp_f32_dpp v69, v76 row_newbcast:6 row_mask:0xf bank_mask:0xf
    s_nop 0
    v_mul_f32 v76, v76, v69
    v_cvt_pk_bf16_f32 v71, v76, v76
    s_nop 1
    v_and_b32_dpp v182, v71, v36 row_newbcast:0 row_mask:0xf bank_mask:0xf
    v_and_b32_dpp v183, v71, v37 row_newbcast:0 row_mask:0xf bank_mask:0xf
    v_and_b32_dpp v184, v71, v38 row_newbcast:0 row_mask:0xf bank_mask:0xf
    v_and_b32_dpp v185, v71, v39 row_newbcast:0 row_mask:0xf bank_mask:0xf
    v_and_b32_dpp v188, v71, v36 row_newbcast:1 row_mask:0xf bank_mask:0xf
    v_and_b32_dpp v189, v71, v37 row_newbcast:1 row_mask:0xf bank_mask:0xf
    v_and_b32_dpp v190, v71, v38 row_newbcast:1 row_mask:0xf bank_mask:0xf
    v_and_b32_dpp v191, v71, v39 row_newbcast:1 row_mask:0xf bank_mask:0xf
    v_mfma_f32_16x16x32_bf16 v[28:31], v[182:185], v[218:221], v[28:31]
    v_and_b32_dpp v194, v71, v36 row_newbcast:2 row_mask:0xf bank_mask:0xf
    v_and_b32_dpp v195, v71, v37 row_newbcast:2 row_mask:0xf bank_mask:0xf
    v_and_b32_dpp v196, v71, v38 row_newbcast:2 row_mask:0xf bank_mask:0xf
    v_and_b32_dpp v197, v71, v39 row_newbcast:2 row_mask:0xf bank_mask:0xf
    v_mfma_f32_16x16x32_bf16 v[28:31], v[188:191], v[224:227], v[28:31]
    v_and_b32_dpp v200, v71, v36 row_newbcast:3 row_mask:0xf bank_mask:0xf
    v_and_b32_dpp v201, v71, v37 row_newbcast:3 row_mask:0xf bank_mask:0xf
    v_and_b32_dpp v202, v71, v38 row_newbcast:3 row_mask:0xf bank_mask:0xf
    v_and_b32_dpp v203, v71, v39 row_newbcast:3 row_mask:0xf bank_mask:0xf
    v_mfma_f32_16x16x32_bf16 v[28:31], v[194:197], v[230:233], v[28:31]
    v_and_b32_dpp v206, v71, v36 row_newbcast:4 row_mask:0xf bank_mask:0xf
    v_and_b32_dpp v207, v71, v37 row_newbcast:4 row_mask:0xf bank_mask:0xf
    v_and_b32_dpp v208, v71, v38 row_newbcast:4 row_mask:0xf bank_mask:0xf
    v_and_b32_dpp v209, v71, v39 row_newbcast:4 row_mask:0xf bank_mask:0xf
    v_mfma_f32_16x16x32_bf16 v[28:31], v[200:203], v[92:95], v[28:31]
    v_and_b32_dpp v212, v71, v36 row_newbcast:5 row_mask:0xf bank_mask:0xf
    v_and_b32_dpp v213, v71, v37 row_newbcast:5 row_mask:0xf bank_mask:0xf
    v_and_b32_dpp v214, v71, v38 row_newbcast:5 row_mask:0xf bank_mask:0xf
    v_and_b32_dpp v215, v71, v39 row_newbcast:5 row_mask:0xf bank_mask:0xf
    v_mfma_f32_16x16x32_bf16 v[28:31], v[206:209], v[98:101], v[28:31]
    s_nop 0
    v_mfma_f32_16x16x32_bf16 v[28:31], v[212:215], v[104:107], v[28:31]
    v_cmp_gt_u32 vcc, 32, v1
    s_cmp_ge_u32 s93, 32
    s_cbranch_scc1 L_noh1
    v_mfma_f32_16x16x32_bf16 v[32:35], v[182:185], v[110:113], v[32:35]
    v_mfma_f32_16x16x32_bf16 v[32:35], v[188:191], v[116:119], v[32:35]
    v_mfma_f32_16x16x32_bf16 v[32:35], v[194:197], v[158:161], v[32:35]
    v_mfma_f32_16x16x32_bf16 v[32:35], v[200:203], v[164:167], v[32:35]
    v_mfma_f32_16x16x32_bf16 v[32:35], v[206:209], v[170:173], v[32:35]
    v_mfma_f32_16x16x32_bf16 v[32:35], v[212:215], v[176:179], v[32:35]
L_noh1:
    s_nop 7
    v_cndmask_b32 v28, v32, v28, vcc
    v_cndmask_b32 v29, v33, v29, vcc
    v_cndmask_b32 v30, v34, v30, vcc
    v_cndmask_b32 v31, v35, v31, vcc
    ds_write_b128 v16, v[28:31] offset:20096
    s_waitcnt lgkmcnt(0)
    s_barrier
    s_cmp_lg_u32 s76, 0
    s_cbranch_scc1 L_nop2
    ds_read_b128 v[122:125], v12 offset:20096
    ds_read_b128 v[126:129], v12 offset:21120
    ds_read_b128 v[130:133], v12 offset:22144
    ds_read_b128 v[134:137], v12 offset:23168
    ds_read_b128 v[138:141], v12 offset:24192
    ds_read_b128 v[142:145], v12 offset:25216
    ds_read_b128 v[146:149], v12 offset:26240
    ds_read_b128 v[150:153], v12 offset:27264
    s_waitcnt lgkmcnt(6)
    v_pk_add_f32 v[122:123], v[122:123], v[126:127]
    v_pk_add_f32 v[124:125], v[124:125], v[128:129]
    s_waitcnt lgkmcnt(4)
    v_pk_add_f32 v[130:131], v[130:131], v[134:135]
    v_pk_add_f32 v[132:133], v[132:133], v[136:137]
    s_waitcnt lgkmcnt(2)
    v_pk_add_f32 v[138:139], v[138:139], v[142:143]
    v_pk_add_f32 v[140:141], v[140:141], v[144:145]
    v_pk_add_f32 v[122:123], v[122:123], v[130:131]
    v_pk_add_f32 v[124:125], v[124:125], v[132:133]
    s_waitcnt lgkmcnt(0)
    v_pk_add_f32 v[146:147], v[146:147], v[150:151]
    v_pk_add_f32 v[148:149], v[148:149], v[152:153]
    v_pk_add_f32 v[138:139], v[138:139], v[146:147]
    v_pk_add_f32 v[140:141], v[140:141], v[148:149]
    v_pk_add_f32 v[122:123], v[122:123], v[138:139]
    v_pk_add_f32 v[124:125], v[124:125], v[140:141]
    buffer_store_dwordx4 v[122:125], v15, s[56:59], s88 offen sc1
    s_branch L_fin
L_none:
    s_waitcnt vmcnt(0)
L_nop2:
    s_cmp_lg_u32 s76, 1
    s_cbranch_scc1 L_fin
    s_cmp_ge_u32 s2, 160
    s_cbranch_scc1 L_fin
    s_mov_b32 s85, 32768
    s_mov_b64 vcc, -1
L_poll2:
    s_mov_b64 exec, vcc
    buffer_load_dwordx4 v[76:79], v12, s[56:59], s90 offen sc1
    s_mov_b64 exec, -1
    s_waitcnt vmcnt(0)
    v_max3_u32 v68, v76, v77, v78
    v_max_u32 v68, v68, v79
    v_cmp_eq_u32 vcc, -1, v68
    s_cbranch_vccz L_got2
    s_sub_u32 s85, s85, 1
    s_cmp_lg_u32 s85, 0
    s_cbranch_scc1 L_poll2
L_got2:
    v_permlane16_swap_b32 v76, v77
    v_permlane16_swap_b32 v78, v79
    v_add_f32 v76, v76, v77
    v_add_f32 v78, v78, v79
    s_nop 1
    v_permlane32_swap_b32 v76, v78
    s_nop 1
    v_add_f32_dpp v76, v76, v76 row_ror:8 row_mask:0xf bank_mask:0xf
    v_add_f32_dpp v78, v78, v78 row_ror:8 row_mask:0xf bank_mask:0xf
    s_nop 0
    v_add_f32_dpp v76, v76, v76 row_ror:4 row_mask:0xf bank_mask:0xf
    v_add_f32_dpp v78, v78, v78 row_ror:4 row_mask:0xf bank_mask:0xf
    s_nop 0
    v_add_f32_dpp v76, v76, v76 row_ror:2 row_mask:0xf bank_mask:0xf
    v_add_f32_dpp v78, v78, v78 row_ror:2 row_mask:0xf bank_mask:0xf
    s_nop 0
    v_add_f32_dpp v76, v76, v76 row_ror:1 row_mask:0xf bank_mask:0xf
    v_add_f32_dpp v78, v78, v78 row_ror:1 row_mask:0xf bank_mask:0xf
    v_cvt_pk_bf16_f32 v76, 0, v76
    v_cvt_pk_bf16_f32 v78, 0, v78
    v_mul_f32 v76, v20, v76
    v_mul_f32 v78, v21, v78
    v_cvt_pk_bf16_f32 v76, 0, v76
    v_cvt_pk_bf16_f32 v78, 0, v78
    v_add_f32 v76, v76, v78
    v_cvt_pk_bf16_f32 v76, v76, v76
    buffer_store_short v76, v19, s[72:75], 0 offen
L_fin:
L_exit:
    s_endpgm
.section .rodata,"a"
.p2align 6
.amdhsa_kernel gated_mix__sliding_block_cached__gqa_block_cached__decode_kernel
  .amdhsa_next_free_vgpr 256
  .amdhsa_next_free_sgpr 102
  .amdhsa_accum_offset 256
  .amdhsa_group_segment_fixed_size 0
  .amdhsa_kernarg_size 112
  .amdhsa_user_sgpr_count 2
  .amdhsa_user_sgpr_kernarg_segment_ptr 1
  .amdhsa_system_sgpr_workgroup_id_x 1
.end_amdhsa_kernel
```
